```python
import torch

def _softmax(x, axis=-1):
    return torch.softmax(x, dim=axis)
def _gelu(x):
    return torch.nn.functional.gelu(x, approximate="tanh")
def _silu(x):
    return torch.nn.functional.silu(x)
def _sigmoid(x):
    return torch.sigmoid(x)
def _layernorm(x, axis=-1, eps=1e-5):
    m = x.mean(dim=axis, keepdim=True)
    v = x.var(dim=axis, keepdim=True, unbiased=False)
    return (x - m) / torch.sqrt(v + eps)
def _scatter_add(tgt, idx, src, axis=0):
    return tgt.clone().index_add_(axis, idx, src)
def _segment_sum(src, seg, n):
    out = torch.zeros((n,) + src.shape[1:], dtype=src.dtype)
    return out.index_add_(0, seg, src)
def _pad(x, pw):
    flat = tuple(v for pair in reversed(pw) for v in pair)
    return torch.nn.functional.pad(x, flat)

kernel_name = 'gather_scatter__cheap_equivariant_egnn__graph'

def setup_inputs():

    _w = (lambda a: (lambda t: t.to(torch.bfloat16) if t.is_floating_point() else t)(torch.as_tensor(a)))
    N, deg, D, De = 10000, 32, 128, max(4, 1)
    E = N * deg
    return {
        "h": _w((lambda *s: torch.randn(*s, dtype=torch.bfloat16) * 0.1)(N, D)),
        "pos": _w((lambda *s: torch.randn(*s, dtype=torch.bfloat16) * 0.8)(N, 3)),
        "e_attr": _w((lambda *s: torch.randn(*s, dtype=torch.bfloat16) * 0.8)(E, De)),
        "src": _w((lambda lo, hi, *s: torch.randint(lo, hi, s))(0, N, E).to(torch.int64)),
        "dst": _w((lambda lo, hi, *s: torch.randint(lo, hi, s))(0, N, E).to(torch.int64)),
        "w_e": _w(0.1 * (lambda *s: torch.randn(*s, dtype=torch.bfloat16) * 0.8)(2 * D + 1 + De, D)),
        "w_x": _w(0.1 * (lambda *s: torch.randn(*s, dtype=torch.bfloat16) * 0.1)(D, 1)),
        "w_h": _w(0.1 * (lambda *s: torch.randn(*s, dtype=torch.bfloat16) * 0.1)(2 * D, D)),
    }

def reference(h, pos, e_attr, src, dst, w_e, w_x, w_h):
    N, D = h.shape[0], h.shape[1]
    diff = pos[dst] - pos[src]
    dist2 = torch.sum(diff * diff, axis=-1, keepdims=True)
    e_in = torch.concatenate([h[dst], h[src], dist2, e_attr], axis=-1)
    m_ij = _silu(e_in @ w_e)
    coord_scale = m_ij @ w_x
    pos_new = pos + _segment_sum(diff * coord_scale, dst, N)
    m_i = _segment_sum(m_ij, dst, N)
    h_new = h + _silu(torch.concatenate([h, m_i], axis=-1) @ w_h)
    return h_new, pos_new
```

```asm
; @launch kernel=egnn_prep_kernel grid=(256,1,1) block=(768,1,1) lds=129280
; @launch kernel=gather_scatter__cheap_equivariant_egnn__graph_kernel grid=(256,1,1) block=(1024,1,1) lds=163840
.amdgcn_target "amdgcn-amd-amdhsa--gfx950"
.text
.globl egnn_prep_kernel
.p2align 12
.type egnn_prep_kernel,@function
egnn_prep_kernel:
    s_cmp_ge_u32 s2, 256
    s_cbranch_scc1 K1_END
    s_load_dwordx16 s[16:31], s[0:1], 0
    s_load_dwordx2 s[32:33], s[0:1], 80
    v_and_b32 v3, 0x3c0, v0
    s_nop 0
    v_readfirstlane_b32 s56, v3
    s_cmp_ge_u32 s2, 253
    s_cbranch_scc1 K1_PREP
    s_cmp_ge_u32 s2, 125
    s_cbranch_scc1 K1_GEMM
    s_mul_i32 s57, s2, 87168
    s_add_u32 s57, s57, 5242880
    s_mov_b32 s62, 87168
    s_mov_b32 s63, 0x20000
    s_cmp_ge_u32 s56, 640
    s_cbranch_scc1 K1_DMA
    s_mul_i32 s34, s2, 10240
    s_lshl_b32 s35, s34, 1
    v_lshlrev_b32 v1, 4, v0
    v_lshlrev_b32 v2, 2, v0
    v_lshlrev_b32 v3, 5, v0
    v_mov_b32 v20, 0
    ds_write_b32 v2, v20 offset:0
    s_waitcnt lgkmcnt(0)
    s_add_u32 s36, s24, s34
    s_addc_u32 s37, s25, 0
    s_add_u32 s38, s22, s34
    s_addc_u32 s39, s23, 0
    global_load_dwordx4 v[4:7], v1, s[36:37]
    global_load_dwordx4 v[8:11], v1, s[38:39]
    s_add_u32 s40, s20, s35
    s_addc_u32 s41, s21, 0
    s_barrier
    s_mul_i32 s58, s56, 5
    s_lshr_b32 s58, s58, 6
    v_mov_b32 v57, 4
    s_mov_b32 s55, 879609344
    s_movk_i32 s54, 399
    s_movk_i32 s6, 128
    s_mov_b32 s7, 1717986
    s_mov_b32 s35, 5547
    v_and_b32 v72, 15, v0
    v_bfe_u32 v70, v0, 4, 2
    v_lshl_add_u32 v70, s58, 2, v70
    v_lshl_add_u32 v1, v70, 4, v72
    v_add_lshl_u32 v71, v1, v70, 2
    v_mul_u32_u24 v2, 17, v72
    v_bfe_u32 v2, v2, 3, 4
    v_lshl_add_u32 v2, v70, 4, v2
    v_lshlrev_b32 v72, 2, v72
    v_lshlrev_b32 v70, 2, v70
    v_lshlrev_b32 v69, 1, v71
    v_lshlrev_b32 v1, 4, v1
    s_mov_b32 s3, 0x06050100
    v_mov_b32 v73, 67840
    s_mov_b32 s52, 0x11111111
    s_mov_b32 s53, 0x11111111
    s_add_u32 s60, s32, s57
    s_addc_u32 s61, s33, 0
    s_waitcnt vmcnt(1)
    global_load_dwordx4 v[76:79], v3, s[40:41]
    global_load_dwordx4 v[80:83], v3, s[40:41] offset:16
    v_mul_hi_u32 v44, v4, s55
    v_mul_hi_u32 v45, v5, s55
    v_mul_hi_u32 v46, v6, s55
    v_mul_hi_u32 v47, v7, s55
    v_lshrrev_b32 v48, 1, v44
    v_and_b32 v48, 0x3fc, v48
    ds_add_rtn_u32 v52, v48, v57 offset:0
    v_lshrrev_b32 v49, 1, v45
    v_and_b32 v49, 0x3fc, v49
    ds_add_rtn_u32 v53, v49, v57 offset:0
    v_lshrrev_b32 v50, 1, v46
    v_and_b32 v50, 0x3fc, v50
    ds_add_rtn_u32 v54, v50, v57 offset:0
    v_lshrrev_b32 v51, 1, v47
    v_and_b32 v51, 0x3fc, v51
    ds_add_rtn_u32 v55, v51, v57 offset:0
    v_lshl_add_u32 v60, v4, 7, s6
    v_mad_u32_u24 v60, v44, s54, v60
    v_bfe_u32 v60, v60, 7, 6
    v_lshl_add_u32 v61, v5, 7, s6
    v_mad_u32_u24 v61, v45, s54, v61
    v_bfe_u32 v61, v61, 7, 6
    v_lshl_add_u32 v62, v6, 7, s6
    v_mad_u32_u24 v62, v46, s54, v62
    v_bfe_u32 v62, v62, 7, 6
    v_lshl_add_u32 v63, v7, 7, s6
    v_mad_u32_u24 v63, v47, s54, v63
    v_bfe_u32 v63, v63, 7, 6
    s_waitcnt vmcnt(2)
    v_mul_hi_u32 v4, v8, s7
    v_mul_hi_u32 v5, v9, s7
    v_mul_hi_u32 v6, v10, s7
    v_mul_hi_u32 v7, v11, s7
    v_lshl_or_b32 v60, v4, 6, v60
    v_lshl_or_b32 v60, v8, 10, v60
    v_lshl_or_b32 v61, v5, 6, v61
    v_lshl_or_b32 v61, v9, 10, v61
    v_lshl_or_b32 v62, v6, 6, v62
    v_lshl_or_b32 v62, v10, 10, v62
    v_lshl_or_b32 v63, v7, 6, v63
    v_lshl_or_b32 v63, v11, 10, v63
    s_waitcnt lgkmcnt(0)
    v_cmp_lt_u32 s[8:9], 63, v52
    v_cmp_lt_u32 s[10:11], 63, v53
    v_cmp_lt_u32 s[12:13], 63, v54
    v_cmp_lt_u32 s[14:15], 63, v55
    v_mad_u32_u24 v84, v48, 17, v52
    v_lshlrev_b32 v88, 1, v84
    v_mad_u32_u24 v85, v49, 17, v53
    v_lshlrev_b32 v89, 1, v85
    v_mad_u32_u24 v86, v50, 17, v54
    v_lshlrev_b32 v90, 1, v86
    v_mad_u32_u24 v87, v51, 17, v55
    v_lshlrev_b32 v91, 1, v87
    s_not_b64 exec, s[8:9]
    ds_write_b32 v84, v60 offset:2560
    s_not_b64 exec, s[10:11]
    ds_write_b32 v85, v61 offset:2560
    s_not_b64 exec, s[12:13]
    ds_write_b32 v86, v62 offset:2560
    s_not_b64 exec, s[14:15]
    ds_write_b32 v87, v63 offset:2560
    s_or_b64 s[48:49], s[8:9], s[10:11]
    s_or_b64 s[50:51], s[12:13], s[14:15]
    s_mov_b64 s[66:67], 0
    s_or_b64 s[64:65], s[48:49], s[50:51]
    s_cbranch_scc0 K1_BIN_NOOV
    s_mov_b32 s6, 34816
    s_mov_b64 exec, s[8:9]
    v_lshrrev_b32 v44, 2, v48
    v_and_b32 v44, 0xfc, v44
    ds_add_rtn_u32 v52, v44, v57 offset:1024
    v_and_b32 v4, 12, v48
    v_and_b32 v8, 63, v60
    v_lshl_add_u32 v4, v4, 4, v8
    s_mov_b64 exec, s[10:11]
    v_lshrrev_b32 v45, 2, v49
    v_and_b32 v45, 0xfc, v45
    ds_add_rtn_u32 v53, v45, v57 offset:1024
    v_and_b32 v5, 12, v49
    v_and_b32 v9, 63, v61
    v_lshl_add_u32 v5, v5, 4, v9
    s_mov_b64 exec, s[12:13]
    v_lshrrev_b32 v46, 2, v50
    v_and_b32 v46, 0xfc, v46
    ds_add_rtn_u32 v54, v46, v57 offset:1024
    v_and_b32 v6, 12, v50
    v_and_b32 v10, 63, v62
    v_lshl_add_u32 v6, v6, 4, v10
    s_mov_b64 exec, s[14:15]
    v_lshrrev_b32 v47, 2, v51
    v_and_b32 v47, 0xfc, v47
    ds_add_rtn_u32 v55, v47, v57 offset:1024
    v_and_b32 v7, 12, v51
    v_and_b32 v11, 63, v63
    v_lshl_add_u32 v7, v7, 4, v11
    s_waitcnt lgkmcnt(0)
    s_mov_b64 exec, s[8:9]
    v_cmp_lt_u32 s[8:9], 59, v52
    v_min_u32 v8, 60, v52
    v_mad_u32_u24 v84, v44, 17, v8
    v_mul_u32_u24 v8, 17, v8
    ds_write_b32 v84, v60 offset:19968
    v_cndmask_b32 v4, v4, -1, s[8:9]
    v_bfe_u32 v8, v8, 5, 4
    v_lshl_add_u32 v8, v44, 2, v8
    ds_write_b8 v8, v4 offset:1536
    v_lshl_add_u32 v88, v84, 1, s6
    s_or_b64 s[66:67], s[66:67], s[8:9]
    s_mov_b64 exec, s[10:11]
    v_cmp_lt_u32 s[10:11], 59, v53
    v_min_u32 v9, 60, v53
    v_mad_u32_u24 v85, v45, 17, v9
    v_mul_u32_u24 v9, 17, v9
    ds_write_b32 v85, v61 offset:19968
    v_cndmask_b32 v5, v5, -1, s[10:11]
    v_bfe_u32 v9, v9, 5, 4
    v_lshl_add_u32 v9, v45, 2, v9
    ds_write_b8 v9, v5 offset:1536
    v_lshl_add_u32 v89, v85, 1, s6
    s_or_b64 s[66:67], s[66:67], s[10:11]
    s_mov_b64 exec, s[12:13]
    v_cmp_lt_u32 s[12:13], 59, v54
    v_min_u32 v10, 60, v54
    v_mad_u32_u24 v86, v46, 17, v10
    v_mul_u32_u24 v10, 17, v10
    ds_write_b32 v86, v62 offset:19968
    v_cndmask_b32 v6, v6, -1, s[12:13]
    v_bfe_u32 v10, v10, 5, 4
    v_lshl_add_u32 v10, v46, 2, v10
    ds_write_b8 v10, v6 offset:1536
    v_lshl_add_u32 v90, v86, 1, s6
    s_or_b64 s[66:67], s[66:67], s[12:13]
    s_mov_b64 exec, s[14:15]
    v_cmp_lt_u32 s[14:15], 59, v55
    v_min_u32 v11, 60, v55
    v_mad_u32_u24 v87, v47, 17, v11
    v_mul_u32_u24 v11, 17, v11
    ds_write_b32 v87, v63 offset:19968
    v_cndmask_b32 v7, v7, -1, s[14:15]
    v_bfe_u32 v11, v11, 5, 4
    v_lshl_add_u32 v11, v47, 2, v11
    ds_write_b8 v11, v7 offset:1536
    v_lshl_add_u32 v91, v87, 1, s6
    s_or_b64 s[66:67], s[66:67], s[14:15]
    s_cbranch_scc1 K1_BIN_SPILL
K1_BIN_NOOV:
    s_mov_b64 exec, -1
    v_and_b32 v64, 3, v0
    v_lshlrev_b32 v64, 2, v64
    v_and_b32 v65, 0xfc, v0
    v_mad_u32_u24 v66, v65, 17, v64
    v_lshlrev_b32 v67, 1, v66
    v_lshl_add_u32 v68, v65, 4, v64
    v_lshlrev_b32 v68, 2, v68
    s_mov_b32 s7, 70784
    s_mov_b32 s6, 4
    s_waitcnt vmcnt(0)
    s_not_b64 exec, s[8:9]
    ds_write_b64 v88, v[76:77] offset:24320
    s_not_b64 exec, s[10:11]
    ds_write_b64 v89, v[78:79] offset:24320
    s_not_b64 exec, s[12:13]
    ds_write_b64 v90, v[80:81] offset:24320
    s_not_b64 exec, s[14:15]
    ds_write_b64 v91, v[82:83] offset:24320
    s_mov_b64 exec, -1
    s_mov_b32 s4, 5248
    s_mov_b32 s5, 9344
    s_waitcnt lgkmcnt(0)
    s_barrier
    s_cmp_ge_u32 s56, 256
    s_cbranch_scc1 K1_BIN_R
    ds_read_b32 v74, v65 offset:1024
    ds_read_b32 v75, v66 offset:19968
    ds_read_b64 v[92:93], v67 offset:59136
K1_BIN_R:
    ds_read2_b32 v[12:13], v70 offset0:0 offset1:4
    ds_read2_b32 v[14:15], v70 offset0:8 offset1:12
    ds_read2_b32 v[16:17], v70 offset0:16 offset1:20
    ds_read_b32 v20, v71 offset:2560
    ds_read_b32 v21, v71 offset:2832
    ds_read_b32 v22, v71 offset:3104
    ds_read_b32 v23, v71 offset:3376
    ds_read_b32 v24, v71 offset:3648
    s_waitcnt lgkmcnt(5)
    v_cmp_gt_u32 s[36:37], v12, v72
    v_cmp_gt_u32 s[38:39], v13, v72
    v_cmp_gt_u32 s[40:41], v14, v72
    v_cmp_gt_u32 s[42:43], v15, v72
    v_cmp_gt_u32 s[44:45], v16, v72
    s_waitcnt lgkmcnt(4)
    v_cndmask_b32 v20, 0, v20, s[36:37]
    s_and_b64 s[36:37], s[36:37], s[52:53]
    ds_read_b64 v[96:97], v69 offset:24320
    v_lshrrev_b32 v28, 10, v20
    v_mad_u32_u24 v28, v28, 6, v73
    v_and_b32 v29, -4, v28
    ds_read2_b32 v[98:99], v29 offset0:0 offset1:1
    buffer_store_byte v20, v2, s[60:63], 0 offen offset:0 sc1
    s_waitcnt lgkmcnt(5)
    v_cndmask_b32 v21, 0, v21, s[38:39]
    s_and_b64 s[38:39], s[38:39], s[52:53]
    ds_read_b64 v[100:101], v69 offset:24864
    v_lshrrev_b32 v30, 10, v21
    v_mad_u32_u24 v30, v30, 6, v73
    v_and_b32 v31, -4, v30
    ds_read2_b32 v[102:103], v31 offset0:0 offset1:1
    buffer_store_byte v21, v2, s[60:63], 0 offen offset:64 sc1
    s_waitcnt lgkmcnt(6)
    v_cndmask_b32 v22, 0, v22, s[40:41]
    s_and_b64 s[40:41], s[40:41], s[52:53]
    ds_read_b64 v[104:105], v69 offset:25408
    v_lshrrev_b32 v32, 10, v22
    v_mad_u32_u24 v32, v32, 6, v73
    v_and_b32 v33, -4, v32
    ds_read2_b32 v[106:107], v33 offset0:0 offset1:1
    buffer_store_byte v22, v2, s[60:63], 0 offen offset:128 sc1
    s_waitcnt lgkmcnt(7)
    v_cndmask_b32 v23, 0, v23, s[42:43]
    s_and_b64 s[42:43], s[42:43], s[52:53]
    ds_read_b64 v[108:109], v69 offset:25952
    v_lshrrev_b32 v34, 10, v23
    v_mad_u32_u24 v34, v34, 6, v73
    v_and_b32 v35, -4, v34
    ds_read2_b32 v[110:111], v35 offset0:0 offset1:1
    buffer_store_byte v23, v2, s[60:63], 0 offen offset:192 sc1
    s_waitcnt lgkmcnt(8)
    v_cndmask_b32 v24, 0, v24, s[44:45]
    s_and_b64 s[44:45], s[44:45], s[52:53]
    ds_read_b64 v[112:113], v69 offset:26496
    v_lshrrev_b32 v36, 10, v24
    v_mad_u32_u24 v36, v36, 6, v73
    v_and_b32 v37, -4, v36
    ds_read2_b32 v[114:115], v37 offset0:0 offset1:1
    buffer_store_byte v24, v2, s[60:63], 0 offen offset:256 sc1
    s_waitcnt lgkmcnt(8)
    v_alignbyte_b32 v98, v99, v98, v28
    v_alignbyte_b32 v99, v99, v99, v28
    v_perm_b32 v99, v20, v99, s3
    s_mul_i32 exec_lo, s36, 15
    s_mul_i32 exec_hi, s37, 15
    buffer_store_dwordx4 v[96:99], v1, s[60:63], s4 offen offset:0 sc1
    s_mov_b64 exec, -1
    s_waitcnt lgkmcnt(6)
    v_alignbyte_b32 v102, v103, v102, v30
    v_alignbyte_b32 v103, v103, v103, v30
    v_perm_b32 v103, v21, v103, s3
    s_mul_i32 exec_lo, s38, 15
    s_mul_i32 exec_hi, s39, 15
    buffer_store_dwordx4 v[100:103], v1, s[60:63], s4 offen offset:1024 sc1
    s_mov_b64 exec, -1
    s_waitcnt lgkmcnt(4)
    v_alignbyte_b32 v106, v107, v106, v32
    v_alignbyte_b32 v107, v107, v107, v32
    v_perm_b32 v107, v22, v107, s3
    s_mul_i32 exec_lo, s40, 15
    s_mul_i32 exec_hi, s41, 15
    buffer_store_dwordx4 v[104:107], v1, s[60:63], s4 offen offset:2048 sc1
    s_mov_b64 exec, -1
    s_waitcnt lgkmcnt(2)
    v_alignbyte_b32 v110, v111, v110, v34
    v_alignbyte_b32 v111, v111, v111, v34
    v_perm_b32 v111, v23, v111, s3
    s_mul_i32 exec_lo, s42, 15
    s_mul_i32 exec_hi, s43, 15
    buffer_store_dwordx4 v[108:111], v1, s[60:63], s4 offen offset:3072 sc1
    s_mov_b64 exec, -1
    s_waitcnt lgkmcnt(0)
    v_alignbyte_b32 v114, v115, v114, v36
    v_alignbyte_b32 v115, v115, v115, v36
    v_perm_b32 v115, v24, v115, s3
    s_mul_i32 exec_lo, s44, 15
    s_mul_i32 exec_hi, s45, 15
    buffer_store_dwordx4 v[112:115], v1, s[60:63], s5 offen offset:0 sc1
    s_mov_b64 exec, -1
    s_cmp_ge_u32 s56, 256
    s_cbranch_scc1 K1_BIN_OE
K1_BIN_OL:
    v_cmp_gt_u32 s[36:37], v74, v64
    v_add_u32 v64, 16, v64
    v_add_u32 v66, 16, v66
    v_cndmask_b32 v75, 0, v75, s[36:37]
    s_and_b64 s[36:37], s[36:37], s[52:53]
    s_cbranch_scc0 K1_BIN_OE
    v_lshrrev_b32 v44, 10, v75
    v_mad_u32_u24 v44, v44, 6, v73
    v_and_b32 v45, -4, v44
    ds_read2_b32 v[94:95], v45 offset0:0 offset1:1
    v_add_u32 v67, 32, v67
    s_sub_u32 s6, s6, 1
    s_waitcnt lgkmcnt(0)
    v_alignbyte_b32 v94, v95, v94, v44
    v_alignbyte_b32 v95, v95, v95, v44
    v_perm_b32 v95, v75, v95, s3
    s_mul_i32 exec_lo, s36, 15
    s_mul_i32 exec_hi, s37, 15
    buffer_store_dwordx4 v[92:95], v68, s[60:63], s7 offen sc1
    s_mov_b64 exec, -1
    v_cmp_gt_u32 vcc, v74, v64
    s_cmp_eq_u32 s6, 0
    s_cbranch_scc1 K1_BIN_OE
    s_cbranch_vccz K1_BIN_OE
    v_add_u32 v68, 64, v68
    ds_read_b32 v75, v66 offset:19968
    ds_read_b64 v[92:93], v67 offset:59136
    s_waitcnt lgkmcnt(0)
    s_branch K1_BIN_OL
K1_BIN_OE:
    s_cmp_eq_u64 s[66:67], 0
    s_cbranch_scc0 K1_BIN_SP2
K1_BIN_END:
    s_branch K1_TAIL
K1_DMA:
    s_sub_u32 s58, s56, 640
    s_mul_i32 s59, s58, 480
    v_and_b32 v4, 63, v0
    v_lshlrev_b32 v4, 4, v4
    s_mov_b32 s46, 60000
    s_mov_b32 s47, 0x20000
    s_add_u32 m0, s59, 67840
    s_mov_b32 s4, 5248
    s_mov_b32 s5, 9344
    s_waitcnt lgkmcnt(0)
    s_mov_b32 s44, s18
    s_mov_b32 s45, s19
    s_barrier
    buffer_load_dwordx4 v4, s[44:47], s59 offen offset:0 lds
    buffer_load_dwordx4 v4, s[44:47], s59 offen offset:1024 lds
    buffer_load_dwordx4 v4, s[44:47], s59 offen offset:2048 lds
    buffer_load_dwordx4 v4, s[44:47], s59 offen offset:3072 lds
    s_add_u32 m0, m0, 4096
    s_add_u32 s59, s59, 4096
    buffer_load_dwordx4 v4, s[44:47], s59 offen offset:0 lds
    buffer_load_dwordx4 v4, s[44:47], s59 offen offset:1024 lds
    buffer_load_dwordx4 v4, s[44:47], s59 offen offset:2048 lds
    buffer_load_dwordx4 v4, s[44:47], s59 offen offset:3072 lds
    s_add_u32 m0, m0, 4096
    s_add_u32 s59, s59, 4096
    buffer_load_dwordx4 v4, s[44:47], s59 offen offset:0 lds
    buffer_load_dwordx4 v4, s[44:47], s59 offen offset:1024 lds
    buffer_load_dwordx4 v4, s[44:47], s59 offen offset:2048 lds
    buffer_load_dwordx4 v4, s[44:47], s59 offen offset:3072 lds
    s_add_u32 m0, m0, 4096
    s_add_u32 s59, s59, 4096
    buffer_load_dwordx4 v4, s[44:47], s59 offen offset:0 lds
    buffer_load_dwordx4 v4, s[44:47], s59 offen offset:1024 lds
    buffer_load_dwordx4 v4, s[44:47], s59 offen offset:2048 lds
    buffer_load_dwordx4 v4, s[44:47], s59 offen offset:3072 lds
    s_add_u32 m0, m0, 4096
    s_add_u32 s59, s59, 4096
    buffer_load_dwordx4 v4, s[44:47], s59 offen offset:0 lds
    buffer_load_dwordx4 v4, s[44:47], s59 offen offset:1024 lds
    buffer_load_dwordx4 v4, s[44:47], s59 offen offset:2048 lds
    buffer_load_dwordx4 v4, s[44:47], s59 offen offset:3072 lds
    s_add_u32 m0, m0, 4096
    s_add_u32 s59, s59, 4096
    buffer_load_dwordx4 v4, s[44:47], s59 offen offset:0 lds
    buffer_load_dwordx4 v4, s[44:47], s59 offen offset:1024 lds
    buffer_load_dwordx4 v4, s[44:47], s59 offen offset:2048 lds
    buffer_load_dwordx4 v4, s[44:47], s59 offen offset:3072 lds
    s_add_u32 m0, m0, 4096
    s_add_u32 s59, s59, 4096
    buffer_load_dwordx4 v4, s[44:47], s59 offen offset:0 lds
    buffer_load_dwordx4 v4, s[44:47], s59 offen offset:1024 lds
    buffer_load_dwordx4 v4, s[44:47], s59 offen offset:2048 lds
    buffer_load_dwordx4 v4, s[44:47], s59 offen offset:3072 lds
    s_add_u32 m0, m0, 4096
    s_add_u32 s59, s59, 4096
    buffer_load_dwordx4 v4, s[44:47], s59 offen offset:0 lds
    buffer_load_dwordx4 v4, s[44:47], s59 offen offset:1024 lds
    s_mul_i32 s55, s58, 7
    s_lshr_b32 s55, s55, 6
    s_add_u32 s55, s55, 50
    v_and_b32 v72, 15, v0
    v_bfe_u32 v70, v0, 4, 2
    v_lshl_add_u32 v70, s55, 2, v70
    v_lshl_add_u32 v1, v70, 4, v72
    v_add_lshl_u32 v71, v1, v70, 2
    v_mul_u32_u24 v2, 17, v72
    v_bfe_u32 v2, v2, 3, 4
    v_lshl_add_u32 v2, v70, 4, v2
    v_lshlrev_b32 v72, 2, v72
    v_lshlrev_b32 v70, 2, v70
    v_lshlrev_b32 v69, 1, v71
    v_lshlrev_b32 v1, 4, v1
    s_mov_b32 s3, 0x06050100
    v_mov_b32 v73, 67840
    s_mov_b32 s52, 0x11111111
    s_mov_b32 s53, 0x11111111
    s_add_u32 s60, s32, s57
    s_addc_u32 s61, s33, 0
    s_lshl_b32 s6, s58, 4
    s_add_u32 s6, s6, 4096
    s_cmp_eq_u32 s58, 0
    s_cselect_b64 s[8:9], -1, 15
    s_cselect_b32 s7, 256, 0
    v_add_u32 v3, s7, v4
    s_waitcnt vmcnt(0)
    s_barrier
    ds_read_b128 v[128:131], v3 offset:1280
    ds_read2_b32 v[12:13], v70 offset0:0 offset1:4
    ds_read2_b32 v[14:15], v70 offset0:8 offset1:12
    ds_read2_b32 v[16:17], v70 offset0:16 offset1:20
    ds_read2_b32 v[18:19], v70 offset0:24 offset1:28
    ds_read_b32 v20, v71 offset:2560
    ds_read_b32 v21, v71 offset:2832
    ds_read_b32 v22, v71 offset:3104
    ds_read_b32 v23, v71 offset:3376
    ds_read_b32 v24, v71 offset:3648
    ds_read_b32 v25, v71 offset:3920
    ds_read_b32 v26, v71 offset:4192
    s_waitcnt lgkmcnt(7)
    v_cmp_gt_u32 s[36:37], v12, v72
    v_cmp_gt_u32 s[38:39], v13, v72
    v_cmp_gt_u32 s[40:41], v14, v72
    v_cmp_gt_u32 s[42:43], v15, v72
    v_cmp_gt_u32 s[44:45], v16, v72
    v_cmp_gt_u32 s[46:47], v17, v72
    v_cmp_gt_u32 s[48:49], v18, v72
    s_waitcnt lgkmcnt(6)
    v_cndmask_b32 v20, 0, v20, s[36:37]
    s_and_b64 s[36:37], s[36:37], s[52:53]
    ds_read_b64 v[96:97], v69 offset:24320
    v_lshrrev_b32 v28, 10, v20
    v_mad_u32_u24 v28, v28, 6, v73
    v_and_b32 v29, -4, v28
    ds_read2_b32 v[98:99], v29 offset0:0 offset1:1
    buffer_store_byte v20, v2, s[60:63], 0 offen offset:0 sc1
    s_waitcnt lgkmcnt(7)
    v_cndmask_b32 v21, 0, v21, s[38:39]
    s_and_b64 s[38:39], s[38:39], s[52:53]
    ds_read_b64 v[100:101], v69 offset:24864
    v_lshrrev_b32 v30, 10, v21
    v_mad_u32_u24 v30, v30, 6, v73
    v_and_b32 v31, -4, v30
    ds_read2_b32 v[102:103], v31 offset0:0 offset1:1
    buffer_store_byte v21, v2, s[60:63], 0 offen offset:64 sc1
    s_waitcnt lgkmcnt(8)
    v_cndmask_b32 v22, 0, v22, s[40:41]
    s_and_b64 s[40:41], s[40:41], s[52:53]
    ds_read_b64 v[104:105], v69 offset:25408
    v_lshrrev_b32 v32, 10, v22
    v_mad_u32_u24 v32, v32, 6, v73
    v_and_b32 v33, -4, v32
    ds_read2_b32 v[106:107], v33 offset0:0 offset1:1
    buffer_store_byte v22, v2, s[60:63], 0 offen offset:128 sc1
    s_waitcnt lgkmcnt(9)
    v_cndmask_b32 v23, 0, v23, s[42:43]
    s_and_b64 s[42:43], s[42:43], s[52:53]
    ds_read_b64 v[108:109], v69 offset:25952
    v_lshrrev_b32 v34, 10, v23
    v_mad_u32_u24 v34, v34, 6, v73
    v_and_b32 v35, -4, v34
    ds_read2_b32 v[110:111], v35 offset0:0 offset1:1
    buffer_store_byte v23, v2, s[60:63], 0 offen offset:192 sc1
    s_waitcnt lgkmcnt(10)
    v_cndmask_b32 v24, 0, v24, s[44:45]
    s_and_b64 s[44:45], s[44:45], s[52:53]
    ds_read_b64 v[112:113], v69 offset:26496
    v_lshrrev_b32 v36, 10, v24
    v_mad_u32_u24 v36, v36, 6, v73
    v_and_b32 v37, -4, v36
    ds_read2_b32 v[114:115], v37 offset0:0 offset1:1
    buffer_store_byte v24, v2, s[60:63], 0 offen offset:256 sc1
    s_waitcnt lgkmcnt(11)
    v_cndmask_b32 v25, 0, v25, s[46:47]
    s_and_b64 s[46:47], s[46:47], s[52:53]
    ds_read_b64 v[116:117], v69 offset:27040
    v_lshrrev_b32 v38, 10, v25
    v_mad_u32_u24 v38, v38, 6, v73
    v_and_b32 v39, -4, v38
    ds_read2_b32 v[118:119], v39 offset0:0 offset1:1
    buffer_store_byte v25, v2, s[60:63], 0 offen offset:320 sc1
    s_waitcnt lgkmcnt(12)
    v_cndmask_b32 v26, 0, v26, s[48:49]
    s_and_b64 s[48:49], s[48:49], s[52:53]
    ds_read_b64 v[120:121], v69 offset:27584
    v_lshrrev_b32 v40, 10, v26
    v_mad_u32_u24 v40, v40, 6, v73
    v_and_b32 v41, -4, v40
    ds_read2_b32 v[122:123], v41 offset0:0 offset1:1
    buffer_store_byte v26, v2, s[60:63], 0 offen offset:384 sc1
    s_waitcnt lgkmcnt(12)
    v_alignbyte_b32 v98, v99, v98, v28
    v_alignbyte_b32 v99, v99, v99, v28
    v_perm_b32 v99, v20, v99, s3
    s_mul_i32 exec_lo, s36, 15
    s_mul_i32 exec_hi, s37, 15
    buffer_store_dwordx4 v[96:99], v1, s[60:63], s4 offen offset:0 sc1
    s_mov_b64 exec, -1
    s_waitcnt lgkmcnt(10)
    v_alignbyte_b32 v102, v103, v102, v30
    v_alignbyte_b32 v103, v103, v103, v30
    v_perm_b32 v103, v21, v103, s3
    s_mul_i32 exec_lo, s38, 15
    s_mul_i32 exec_hi, s39, 15
    buffer_store_dwordx4 v[100:103], v1, s[60:63], s4 offen offset:1024 sc1
    s_mov_b64 exec, -1
    s_waitcnt lgkmcnt(8)
    v_alignbyte_b32 v106, v107, v106, v32
    v_alignbyte_b32 v107, v107, v107, v32
    v_perm_b32 v107, v22, v107, s3
    s_mul_i32 exec_lo, s40, 15
    s_mul_i32 exec_hi, s41, 15
    buffer_store_dwordx4 v[104:107], v1, s[60:63], s4 offen offset:2048 sc1
    s_mov_b64 exec, -1
    s_waitcnt lgkmcnt(6)
    v_alignbyte_b32 v110, v111, v110, v34
    v_alignbyte_b32 v111, v111, v111, v34
    v_perm_b32 v111, v23, v111, s3
    s_mul_i32 exec_lo, s42, 15
    s_mul_i32 exec_hi, s43, 15
    buffer_store_dwordx4 v[108:111], v1, s[60:63], s4 offen offset:3072 sc1
    s_mov_b64 exec, -1
    s_waitcnt lgkmcnt(4)
    v_alignbyte_b32 v114, v115, v114, v36
    v_alignbyte_b32 v115, v115, v115, v36
    v_perm_b32 v115, v24, v115, s3
    s_mul_i32 exec_lo, s44, 15
    s_mul_i32 exec_hi, s45, 15
    buffer_store_dwordx4 v[112:115], v1, s[60:63], s5 offen offset:0 sc1
    s_mov_b64 exec, -1
    s_waitcnt lgkmcnt(2)
    v_alignbyte_b32 v118, v119, v118, v38
    v_alignbyte_b32 v119, v119, v119, v38
    v_perm_b32 v119, v25, v119, s3
    s_mul_i32 exec_lo, s46, 15
    s_mul_i32 exec_hi, s47, 15
    buffer_store_dwordx4 v[116:119], v1, s[60:63], s5 offen offset:1024 sc1
    s_mov_b64 exec, -1
    s_waitcnt lgkmcnt(0)
    v_alignbyte_b32 v122, v123, v122, v40
    v_alignbyte_b32 v123, v123, v123, v40
    v_perm_b32 v123, v26, v123, s3
    s_mul_i32 exec_lo, s48, 15
    s_mul_i32 exec_hi, s49, 15
    buffer_store_dwordx4 v[120:123], v1, s[60:63], s5 offen offset:2048 sc1
    s_mov_b64 exec, -1
    s_mov_b64 exec, s[8:9]
    buffer_store_dwordx4 v[128:131], v4, s[60:63], s6 offen sc1
    s_branch K1_TAIL
.p2align 12
K1_GEMM:
    s_sub_u32 s34, s2, 125
    s_bfe_u32 s35, s34, 0x10003
    s_lshr_b32 s36, s34, 4
    s_mul_i32 s36, s36, 160
    s_and_b32 s37, s2, 7
    s_mul_i32 s63, s37, 1250
    s_add_u32 s36, s36, s63
    v_and_b32 v40, 63, v0
    v_lshrrev_b32 v2, 4, v40
    v_and_b32 v3, 15, v0
    s_mov_b32 s47, 0x20000
    s_mov_b32 s51, 0x20000
    s_lshl_b32 s43, s56, 4
    v_bfe_u32 v4, v0, 4, 4
    v_xor_b32 v4, v4, v3
    v_lshlrev_b32 v4, 4, v4
    v_lshl_add_u32 v4, v2, 8, v4
    s_lshl_b32 s38, s36, 8
    s_add_u32 s38, s38, s43
    s_mov_b32 s46, 2560000
    s_cmp_ge_u32 s56, 512
    s_cbranch_scc1 K1_GEMM_2
    v_lshlrev_b32 v5, 2, v2
    v_xor_b32 v5, v5, v3
    v_lshlrev_b32 v5, 4, v5
    v_lshl_add_u32 v5, v2, 8, v5
    s_lshl_b32 s39, s43, 2
    s_add_u32 m0, s43, 32768
    s_lshl_b32 s40, s35, 15
    s_add_u32 s40, s40, s39
    s_mov_b32 s50, 65536
    s_add_u32 s41, s38, 8192
    s_waitcnt lgkmcnt(0)
    s_mov_b32 s44, s16
    s_mov_b32 s45, s17
    s_mov_b32 s48, s26
    s_mov_b32 s49, s27
    buffer_load_dwordx4 v4, s[44:47], s38 offen lds
    s_add_u32 m0, m0, 8192
    s_nop 0
    buffer_load_dwordx4 v4, s[44:47], s41 offen lds
    s_add_u32 m0, s39, 0
    s_nop 0
    buffer_load_dwordx4 v5, s[48:51], s40 offen offset:0 lds
    buffer_load_dwordx4 v5, s[48:51], s40 offen offset:1024 lds
    buffer_load_dwordx4 v5, s[48:51], s40 offen offset:2048 lds
    buffer_load_dwordx4 v5, s[48:51], s40 offen offset:3072 lds
    s_branch K1_GEMM_D
K1_GEMM_2:
    s_add_u32 m0, s43, 40960
    s_add_u32 s38, s38, 8192
    s_waitcnt lgkmcnt(0)
    s_mov_b32 s44, s16
    s_mov_b32 s45, s17
    buffer_load_dwordx4 v4, s[44:47], s38 offen lds
    s_add_u32 m0, m0, 4096
    s_add_u32 s38, s38, 4096
    buffer_load_dwordx4 v4, s[44:47], s38 offen lds
    s_add_u32 m0, m0, 4096
    s_add_u32 s38, s38, 4096
    buffer_load_dwordx4 v4, s[44:47], s38 offen lds
    s_add_u32 m0, m0, 4096
    s_add_u32 s38, s38, 4096
    buffer_load_dwordx4 v4, s[44:47], s38 offen lds
    s_add_u32 m0, m0, 4096
    s_add_u32 s38, s38, 4096
    buffer_load_dwordx4 v4, s[44:47], s38 offen lds
    s_add_u32 m0, m0, 4096
    s_add_u32 s38, s38, 4096
    buffer_load_dwordx4 v4, s[44:47], s38 offen lds
    s_cmp_lg_u32 s36, 9870
    s_cbranch_scc1 K1_GEMM_Z
    v_mov_b32 v5, 0
    v_lshlrev_b32 v6, 2, v40
    v_add_u32 v6, 32768, v6
    ds_write_b32 v6, v5 offset:33280
K1_GEMM_Z:
    s_cmp_lt_u32 s56, 640
    s_cbranch_scc1 K1_GEMM_D
    s_cmp_eq_u32 s56, 640
    s_cbranch_scc1 K1_GEMM_W0
    s_branch K1_GEMM_W1
K1_GEMM_D:
    s_bfe_u32 s42, s56, 0x10006
    s_lshr_b32 s43, s56, 7
    s_add_u32 s66, s63, 1250
    s_cmp_eq_u32 s37, 7
    s_addc_u32 s66, s66, 0
    s_sub_u32 s61, 8, s35
    s_lshl_b32 s66, s66, s61
    v_lshrrev_b32 v41, 5, v40
    v_bfe_u32 v42, v40, 2, 2
    s_lshl_b32 s58, s42, 7
    v_lshlrev_b32 v43, 6, v42
    v_xor_b32 v43, s58, v43
    v_lshl_add_u32 v42, v41, 3, v42
    v_lshl_add_u32 v42, v42, 8, v43
    v_bfe_u32 v43, v40, 4, 1
    v_and_b32 v44, 3, v40
    v_lshl_add_u32 v42, v43, 5, v42
    v_lshl_add_u32 v42, v44, 3, v42
    v_xor_b32 v43, 64, v42
    v_and_b32 v44, 31, v40
    s_lshl_b32 s59, s43, 5
    v_add_u32 v45, s59, v44
    v_xor_b32 v46, v41, v3
    v_lshlrev_b32 v46, 4, v46
    v_lshl_add_u32 v48, v45, 8, v46
    v_add_u32 v48, 32768, v48
    v_xor_b32 v49, 32, v48
    v_xor_b32 v50, 64, v48
    v_xor_b32 v51, 96, v48
    v_xor_b32 v52, 128, v48
    v_xor_b32 v53, 160, v48
    v_xor_b32 v54, 192, v48
    v_xor_b32 v55, 224, v48
    s_add_u32 s60, s36, s59
    s_lshl_b32 s60, s60, s61
    s_add_u32 s61, s61, 2
    v_lshlrev_b32 v56, s61, v41
    v_lshl_add_u32 v56, v44, 2, v56
    v_add_u32 v56, s60, v56
    v_lshrrev_b32 v45, 3, v40
    v_and_b32 v47, 7, v40
    v_lshlrev_b32 v47, 4, v47
    v_lshl_add_u32 v46, v45, 8, v47
    v_add_u32 v46, s60, v46
    s_mul_i32 s59, s56, 72
    s_add_u32 s59, s59, 73728
    s_movk_i32 s58, 144
    v_mad_u32_u24 v45, v45, s58, v47
    v_add_u32 v45, s59, v45
    v_lshl_add_u32 v41, v41, 4, s59
    v_mad_u32_u24 v44, v44, s58, v41
    s_mul_i32 s61, s42, 1310720
    s_add_u32 s61, s61, 4096
    s_lshl_b32 s62, s42, 7
    s_add_u32 s62, s62, 2621440
    s_cmp_eq_u32 s35, 1
    s_cselect_b32 s61, s61, s62
    s_add_u32 s64, s32, s61
    s_addc_u32 s65, s33, 0
    s_mov_b32 s67, 0x20000
    s_movk_i32 s62, 4096
    s_mov_b32 s68, 0xbfb8aa3b
    s_mov_b32 s69, 0xbfb8aa3b
    s_mov_b32 s70, 0xffff0000
    s_setreg_imm32_b32 hwreg(HW_REG_MODE, 4, 2), 0
    s_cmp_ge_u32 s56, 512
    s_cbranch_scc1 K1_GEMM_A
    s_setprio 1
    s_waitcnt vmcnt(0)
K1_GEMM_A:
    s_barrier
    s_cmp_ge_u32 s56, 256
    s_cbranch_scc1 K1_GEMM_L
    s_setprio 2
    ds_read_b128 v[8:11], v48
    ds_read_b64_tr_b16 v[96:97], v42 offset:0
    ds_read_b64_tr_b16 v[98:99], v42 offset:1024
    ds_read_b64_tr_b16 v[128:129], v43 offset:0
    ds_read_b64_tr_b16 v[130:131], v43 offset:1024
    ds_read_b128 v[12:15], v49
    ds_read_b64_tr_b16 v[100:101], v42 offset:4096
    ds_read_b64_tr_b16 v[102:103], v42 offset:5120
    ds_read_b64_tr_b16 v[132:133], v43 offset:4096
    ds_read_b64_tr_b16 v[134:135], v43 offset:5120
    ds_read_b128 v[16:19], v50
    ds_read_b64_tr_b16 v[104:105], v42 offset:8192
    ds_read_b64_tr_b16 v[106:107], v42 offset:9216
    ds_read_b64_tr_b16 v[136:137], v43 offset:8192
    ds_read_b64_tr_b16 v[138:139], v43 offset:9216
    s_waitcnt lgkmcnt(10)
    v_mfma_f32_32x32x16_bf16 v[64:79], v[8:11], v[96:99], 0
    v_mfma_f32_32x32x16_bf16 v[80:95], v[8:11], v[128:131], 0
    ds_read_b128 v[20:23], v51
    ds_read_b64_tr_b16 v[108:109], v42 offset:12288
    ds_read_b64_tr_b16 v[110:111], v42 offset:13312
    ds_read_b64_tr_b16 v[140:141], v43 offset:12288
    ds_read_b64_tr_b16 v[142:143], v43 offset:13312
    s_waitcnt lgkmcnt(10)
    v_mfma_f32_32x32x16_bf16 v[64:79], v[12:15], v[100:103], v[64:79]
    v_mfma_f32_32x32x16_bf16 v[80:95], v[12:15], v[132:135], v[80:95]
    ds_read_b128 v[24:27], v52
    ds_read_b64_tr_b16 v[112:113], v42 offset:16384
    ds_read_b64_tr_b16 v[114:115], v42 offset:17408
    ds_read_b64_tr_b16 v[144:145], v43 offset:16384
    ds_read_b64_tr_b16 v[146:147], v43 offset:17408
    s_waitcnt lgkmcnt(10)
    v_mfma_f32_32x32x16_bf16 v[64:79], v[16:19], v[104:107], v[64:79]
    v_mfma_f32_32x32x16_bf16 v[80:95], v[16:19], v[136:139], v[80:95]
    ds_read_b128 v[28:31], v53
    ds_read_b64_tr_b16 v[116:117], v42 offset:20480
    ds_read_b64_tr_b16 v[118:119], v42 offset:21504
    ds_read_b64_tr_b16 v[148:149], v43 offset:20480
    ds_read_b64_tr_b16 v[150:151], v43 offset:21504
    s_waitcnt lgkmcnt(10)
    v_mfma_f32_32x32x16_bf16 v[64:79], v[20:23], v[108:111], v[64:79]
    v_mfma_f32_32x32x16_bf16 v[80:95], v[20:23], v[140:143], v[80:95]
    ds_read_b128 v[32:35], v54
    ds_read_b64_tr_b16 v[120:121], v42 offset:24576
    ds_read_b64_tr_b16 v[122:123], v42 offset:25600
    ds_read_b64_tr_b16 v[152:153], v43 offset:24576
    ds_read_b64_tr_b16 v[154:155], v43 offset:25600
    s_waitcnt lgkmcnt(10)
    v_mfma_f32_32x32x16_bf16 v[64:79], v[24:27], v[112:115], v[64:79]
    v_mfma_f32_32x32x16_bf16 v[80:95], v[24:27], v[144:147], v[80:95]
    ds_read_b128 v[36:39], v55
    ds_read_b64_tr_b16 v[124:125], v42 offset:28672
    ds_read_b64_tr_b16 v[126:127], v42 offset:29696
    ds_read_b64_tr_b16 v[156:157], v43 offset:28672
    ds_read_b64_tr_b16 v[158:159], v43 offset:29696
    s_waitcnt lgkmcnt(10)
    v_mfma_f32_32x32x16_bf16 v[64:79], v[28:31], v[116:119], v[64:79]
    v_mfma_f32_32x32x16_bf16 v[80:95], v[28:31], v[148:151], v[80:95]
    s_waitcnt lgkmcnt(5)
    v_mfma_f32_32x32x16_bf16 v[64:79], v[32:35], v[120:123], v[64:79]
    v_mfma_f32_32x32x16_bf16 v[80:95], v[32:35], v[152:155], v[80:95]
    s_waitcnt lgkmcnt(0)
    v_mfma_f32_32x32x16_bf16 v[64:79], v[36:39], v[124:127], v[64:79]
    v_mfma_f32_32x32x16_bf16 v[80:95], v[36:39], v[156:159], v[80:95]
    s_barrier
    s_branch K1_GEMM_E
K1_GEMM_W0:
    s_barrier
    s_waitcnt vmcnt(0) lgkmcnt(0)
    s_barrier
    s_branch K1_TAIL
K1_GEMM_L:
    ds_read_b64_tr_b16 v[96:97], v42 offset:0
    ds_read_b64_tr_b16 v[98:99], v42 offset:1024
    ds_read_b64_tr_b16 v[128:129], v43 offset:0
    ds_read_b64_tr_b16 v[130:131], v43 offset:1024
    ds_read_b64_tr_b16 v[100:101], v42 offset:4096
    ds_read_b64_tr_b16 v[102:103], v42 offset:5120
    ds_read_b64_tr_b16 v[132:133], v43 offset:4096
    ds_read_b64_tr_b16 v[134:135], v43 offset:5120
    ds_read_b64_tr_b16 v[104:105], v42 offset:8192
    ds_read_b64_tr_b16 v[106:107], v42 offset:9216
    ds_read_b64_tr_b16 v[136:137], v43 offset:8192
    ds_read_b64_tr_b16 v[138:139], v43 offset:9216
    ds_read_b64_tr_b16 v[108:109], v42 offset:12288
    ds_read_b64_tr_b16 v[110:111], v42 offset:13312
    ds_read_b64_tr_b16 v[140:141], v43 offset:12288
    ds_read_b64_tr_b16 v[142:143], v43 offset:13312
    ds_read_b64_tr_b16 v[112:113], v42 offset:16384
    ds_read_b64_tr_b16 v[114:115], v42 offset:17408
    ds_read_b64_tr_b16 v[144:145], v43 offset:16384
    ds_read_b64_tr_b16 v[146:147], v43 offset:17408
    ds_read_b64_tr_b16 v[116:117], v42 offset:20480
    ds_read_b64_tr_b16 v[118:119], v42 offset:21504
    ds_read_b64_tr_b16 v[148:149], v43 offset:20480
    ds_read_b64_tr_b16 v[150:151], v43 offset:21504
    ds_read_b64_tr_b16 v[120:121], v42 offset:24576
    ds_read_b64_tr_b16 v[122:123], v42 offset:25600
    ds_read_b64_tr_b16 v[152:153], v43 offset:24576
    ds_read_b64_tr_b16 v[154:155], v43 offset:25600
    ds_read_b64_tr_b16 v[124:125], v42 offset:28672
    ds_read_b64_tr_b16 v[126:127], v42 offset:29696
    ds_read_b64_tr_b16 v[156:157], v43 offset:28672
    ds_read_b64_tr_b16 v[158:159], v43 offset:29696
    s_waitcnt vmcnt(0) lgkmcnt(0)
    s_barrier
    ds_read_b128 v[8:11], v48
    ds_read_b128 v[12:15], v49
    ds_read_b128 v[16:19], v50
    ds_read_b128 v[20:23], v51
    ds_read_b128 v[24:27], v52
    ds_read_b128 v[28:31], v53
    ds_read_b128 v[32:35], v54
    ds_read_b128 v[36:39], v55
    s_waitcnt lgkmcnt(7)
    v_mfma_f32_32x32x16_bf16 v[64:79], v[8:11], v[96:99], 0
    v_mfma_f32_32x32x16_bf16 v[80:95], v[8:11], v[128:131], 0
    s_waitcnt lgkmcnt(6)
    v_mfma_f32_32x32x16_bf16 v[64:79], v[12:15], v[100:103], v[64:79]
    v_mfma_f32_32x32x16_bf16 v[80:95], v[12:15], v[132:135], v[80:95]
    s_waitcnt lgkmcnt(5)
    v_mfma_f32_32x32x16_bf16 v[64:79], v[16:19], v[104:107], v[64:79]
    v_mfma_f32_32x32x16_bf16 v[80:95], v[16:19], v[136:139], v[80:95]
    s_waitcnt lgkmcnt(4)
    v_mfma_f32_32x32x16_bf16 v[64:79], v[20:23], v[108:111], v[64:79]
    v_mfma_f32_32x32x16_bf16 v[80:95], v[20:23], v[140:143], v[80:95]
    s_waitcnt lgkmcnt(3)
    v_mfma_f32_32x32x16_bf16 v[64:79], v[24:27], v[112:115], v[64:79]
    v_mfma_f32_32x32x16_bf16 v[80:95], v[24:27], v[144:147], v[80:95]
    s_waitcnt lgkmcnt(2)
    v_mfma_f32_32x32x16_bf16 v[64:79], v[28:31], v[116:119], v[64:79]
    v_mfma_f32_32x32x16_bf16 v[80:95], v[28:31], v[148:151], v[80:95]
    s_waitcnt lgkmcnt(1)
    v_mfma_f32_32x32x16_bf16 v[64:79], v[32:35], v[120:123], v[64:79]
    v_mfma_f32_32x32x16_bf16 v[80:95], v[32:35], v[152:155], v[80:95]
    s_waitcnt lgkmcnt(0)
    v_mfma_f32_32x32x16_bf16 v[64:79], v[36:39], v[124:127], v[64:79]
    v_mfma_f32_32x32x16_bf16 v[80:95], v[36:39], v[156:159], v[80:95]
K1_GEMM_E:
    s_cmp_eq_u32 s35, 1
    s_nop 7
    s_nop 2
    v_pk_mul_f32 v[64:65], v[64:65], s[68:69]
    v_pk_mul_f32 v[66:67], v[66:67], s[68:69]
    v_pk_mul_f32 v[68:69], v[68:69], s[68:69]
    v_pk_mul_f32 v[70:71], v[70:71], s[68:69]
    v_pk_mul_f32 v[72:73], v[72:73], s[68:69]
    v_pk_mul_f32 v[74:75], v[74:75], s[68:69]
    v_pk_mul_f32 v[76:77], v[76:77], s[68:69]
    v_pk_mul_f32 v[78:79], v[78:79], s[68:69]
    v_pk_fma_f32 v[80:81], v[80:81], s[68:69], 0 op_sel_hi:[1,1,0]
    v_pk_fma_f32 v[82:83], v[82:83], s[68:69], 0 op_sel_hi:[1,1,0]
    v_pk_fma_f32 v[84:85], v[84:85], s[68:69], 0 op_sel_hi:[1,1,0]
    v_pk_fma_f32 v[86:87], v[86:87], s[68:69], 0 op_sel_hi:[1,1,0]
    v_pk_fma_f32 v[88:89], v[88:89], s[68:69], 0 op_sel_hi:[1,1,0]
    v_pk_fma_f32 v[90:91], v[90:91], s[68:69], 0 op_sel_hi:[1,1,0]
    v_pk_fma_f32 v[92:93], v[92:93], s[68:69], 0 op_sel_hi:[1,1,0]
    v_pk_fma_f32 v[94:95], v[94:95], s[68:69], 0 op_sel_hi:[1,1,0]
    s_cbranch_scc1 K1_GEMM_B
    v_cvt_pk_bf16_f32 v8, v64, v80
    buffer_store_dword v8, v56, s[64:67], 0 offen offset:0 sc1
    v_cvt_pk_bf16_f32 v9, v65, v81
    buffer_store_dword v9, v56, s[64:67], 0 offen offset:256 sc1
    v_cvt_pk_bf16_f32 v10, v66, v82
    buffer_store_dword v10, v56, s[64:67], 0 offen offset:512 sc1
    v_cvt_pk_bf16_f32 v11, v67, v83
    buffer_store_dword v11, v56, s[64:67], 0 offen offset:768 sc1
    v_cvt_pk_bf16_f32 v12, v68, v84
    buffer_store_dword v12, v56, s[64:67], 0 offen offset:2048 sc1
    v_cvt_pk_bf16_f32 v13, v69, v85
    buffer_store_dword v13, v56, s[64:67], 0 offen offset:2304 sc1
    v_cvt_pk_bf16_f32 v14, v70, v86
    buffer_store_dword v14, v56, s[64:67], 0 offen offset:2560 sc1
    v_cvt_pk_bf16_f32 v15, v71, v87
    buffer_store_dword v15, v56, s[64:67], 0 offen offset:2816 sc1
    v_cvt_pk_bf16_f32 v16, v72, v88
    buffer_store_dword v16, v56, s[64:67], s62 offen offset:0 sc1
    v_cvt_pk_bf16_f32 v17, v73, v89
    buffer_store_dword v17, v56, s[64:67], s62 offen offset:256 sc1
    v_cvt_pk_bf16_f32 v18, v74, v90
    buffer_store_dword v18, v56, s[64:67], s62 offen offset:512 sc1
    v_cvt_pk_bf16_f32 v19, v75, v91
    buffer_store_dword v19, v56, s[64:67], s62 offen offset:768 sc1
    v_cvt_pk_bf16_f32 v20, v76, v92
    buffer_store_dword v20, v56, s[64:67], s62 offen offset:2048 sc1
    v_cvt_pk_bf16_f32 v21, v77, v93
    buffer_store_dword v21, v56, s[64:67], s62 offen offset:2304 sc1
    v_cvt_pk_bf16_f32 v22, v78, v94
    buffer_store_dword v22, v56, s[64:67], s62 offen offset:2560 sc1
    v_cvt_pk_bf16_f32 v23, v79, v95
    buffer_store_dword v23, v56, s[64:67], s62 offen offset:2816 sc1
    s_branch K1_GEMM_S
K1_GEMM_W1:
    s_barrier
    s_waitcnt vmcnt(0) lgkmcnt(0)
    s_barrier
    s_branch K1_TAIL
K1_GEMM_B:
    v_cvt_pk_bf16_f32 v8, v64, 0
    v_add_u32 v47, 0x8000, v80
    v_sub_u32 v47, v47, v8 clamp
    v_and_or_b32 v8, v47, s70, v8
    buffer_store_dword v8, v56, s[64:67], 0 offen offset:0 sc1
    v_cvt_pk_bf16_f32 v9, v65, 0
    v_add_u32 v47, 0x8000, v81
    v_sub_u32 v47, v47, v9 clamp
    v_and_or_b32 v9, v47, s70, v9
    buffer_store_dword v9, v56, s[64:67], 0 offen offset:128 sc1
    v_cvt_pk_bf16_f32 v10, v66, 0
    v_add_u32 v47, 0x8000, v82
    v_sub_u32 v47, v47, v10 clamp
    v_and_or_b32 v10, v47, s70, v10
    buffer_store_dword v10, v56, s[64:67], 0 offen offset:256 sc1
    v_cvt_pk_bf16_f32 v11, v67, 0
    v_add_u32 v47, 0x8000, v83
    v_sub_u32 v47, v47, v11 clamp
    v_and_or_b32 v11, v47, s70, v11
    buffer_store_dword v11, v56, s[64:67], 0 offen offset:384 sc1
    v_cvt_pk_bf16_f32 v12, v68, 0
    v_add_u32 v47, 0x8000, v84
    v_sub_u32 v47, v47, v12 clamp
    v_and_or_b32 v12, v47, s70, v12
    buffer_store_dword v12, v56, s[64:67], 0 offen offset:1024 sc1
    v_cvt_pk_bf16_f32 v13, v69, 0
    v_add_u32 v47, 0x8000, v85
    v_sub_u32 v47, v47, v13 clamp
    v_and_or_b32 v13, v47, s70, v13
    buffer_store_dword v13, v56, s[64:67], 0 offen offset:1152 sc1
    v_cvt_pk_bf16_f32 v14, v70, 0
    v_add_u32 v47, 0x8000, v86
    v_sub_u32 v47, v47, v14 clamp
    v_and_or_b32 v14, v47, s70, v14
    buffer_store_dword v14, v56, s[64:67], 0 offen offset:1280 sc1
    v_cvt_pk_bf16_f32 v15, v71, 0
    v_add_u32 v47, 0x8000, v87
    v_sub_u32 v47, v47, v15 clamp
    v_and_or_b32 v15, v47, s70, v15
    buffer_store_dword v15, v56, s[64:67], 0 offen offset:1408 sc1
    v_cvt_pk_bf16_f32 v16, v72, 0
    v_add_u32 v47, 0x8000, v88
    v_sub_u32 v47, v47, v16 clamp
    v_and_or_b32 v16, v47, s70, v16
    buffer_store_dword v16, v56, s[64:67], 0 offen offset:2048 sc1
    v_cvt_pk_bf16_f32 v17, v73, 0
    v_add_u32 v47, 0x8000, v89
    v_sub_u32 v47, v47, v17 clamp
    v_and_or_b32 v17, v47, s70, v17
    buffer_store_dword v17, v56, s[64:67], 0 offen offset:2176 sc1
    v_cvt_pk_bf16_f32 v18, v74, 0
    v_add_u32 v47, 0x8000, v90
    v_sub_u32 v47, v47, v18 clamp
    v_and_or_b32 v18, v47, s70, v18
    buffer_store_dword v18, v56, s[64:67], 0 offen offset:2304 sc1
    v_cvt_pk_bf16_f32 v19, v75, 0
    v_add_u32 v47, 0x8000, v91
    v_sub_u32 v47, v47, v19 clamp
    v_and_or_b32 v19, v47, s70, v19
    buffer_store_dword v19, v56, s[64:67], 0 offen offset:2432 sc1
    v_cvt_pk_bf16_f32 v20, v76, 0
    v_add_u32 v47, 0x8000, v92
    v_sub_u32 v47, v47, v20 clamp
    v_and_or_b32 v20, v47, s70, v20
    buffer_store_dword v20, v56, s[64:67], 0 offen offset:3072 sc1
    v_cvt_pk_bf16_f32 v21, v77, 0
    v_add_u32 v47, 0x8000, v93
    v_sub_u32 v47, v47, v21 clamp
    v_and_or_b32 v21, v47, s70, v21
    buffer_store_dword v21, v56, s[64:67], 0 offen offset:3200 sc1
    v_cvt_pk_bf16_f32 v22, v78, 0
    v_add_u32 v47, 0x8000, v94
    v_sub_u32 v47, v47, v22 clamp
    v_and_or_b32 v22, v47, s70, v22
    buffer_store_dword v22, v56, s[64:67], 0 offen offset:3328 sc1
    v_cvt_pk_bf16_f32 v23, v79, 0
    v_add_u32 v47, 0x8000, v95
    v_sub_u32 v47, v47, v23 clamp
    v_and_or_b32 v23, v47, s70, v23
    buffer_store_dword v23, v56, s[64:67], 0 offen offset:3456 sc1
K1_GEMM_S:
    s_branch K1_TAIL
.p2align 12
K1_TAIL:
    s_cmp_eq_u32 s56, 0
    s_cbranch_scc1 K2_PAD0
    s_cmp_eq_u32 s56, 64
    s_cbranch_scc1 K2_PAD1
    s_cmp_eq_u32 s56, 128
    s_cbranch_scc1 K2_PAD2
    s_cmp_eq_u32 s56, 192
    s_cbranch_scc1 K2_PAD3
    s_cmp_eq_u32 s56, 256
    s_cbranch_scc1 K2_PAD4
    s_cmp_eq_u32 s56, 320
    s_cbranch_scc1 K2_PAD5
    s_cmp_eq_u32 s56, 384
    s_cbranch_scc1 K2_PAD6
    s_cmp_eq_u32 s56, 448
    s_cbranch_scc1 K2_PAD7
    s_cmp_eq_u32 s56, 512
    s_cbranch_scc1 K2_PAD8
    s_cmp_eq_u32 s56, 576
    s_cbranch_scc1 K2_PAD9
K1_END:
    s_endpgm
.globl gather_scatter__cheap_equivariant_egnn__graph_kernel
.p2align 8
.type gather_scatter__cheap_equivariant_egnn__graph_kernel,@function
gather_scatter__cheap_equivariant_egnn__graph_kernel:
    s_cmp_ge_u32 s2, 256
    s_cbranch_scc1 K2_END
    s_load_dwordx2 s[22:23], s[0:1], 80
    s_load_dwordx4 s[16:19], s[0:1], 0
    s_load_dwordx2 s[20:21], s[0:1], 64
    v_lshrrev_b32 v1, 6, v0
    v_lshrrev_b32 v2, 3, v0
    v_readfirstlane_b32 s3, v1
    s_and_b32 s10, s2, 7
    s_lshl_b32 s8, s10, 5
    s_lshr_b32 s2, s2, 3
    s_or_b32 s2, s2, s8
    s_lshr_b32 s10, s2, 2
    s_mov_b32 s12, 87168
    v_cmp_gt_u32 vcc, 125, v2
    v_and_b32 v9, 7, v0
    v_mul_u32_u24 v112, s12, v2
    v_bfrev_b32 v10, 1
    s_lshl_b32 s8, s2, 4
    s_lshl_b32 s13, s10, 4
    s_sub_u32 s13, s13, s8
    s_add_u32 s13, s13, 4094
    v_cndmask_b32 v112, v10, v112, vcc
    v_and_b32 v77, 1, v0
    v_mad_u32_u24 v3, v77, s13, v112
    v_lshl_add_u32 v108, v9, 1, v3
    v_lshl_add_u32 v113, v9, 4, v112
    s_add_u32 s8, s8, 5242880
    s_lshl_b32 s56, s2, 8
    s_add_u32 s56, s56, 5248128
    s_lshl_b32 s58, s10, 8
    s_add_u32 s58, s58, 5313664
    s_mov_b32 s26, 25165824
    s_mov_b32 s27, 0x20000
    s_lshr_b32 s4, s3, 1
    s_and_b32 s5, s3, 1
    s_lshl_b32 s11, s2, 3
    v_and_b32 v2, 7, v2
    v_lshlrev_b32 v2, 8, v2
    v_lshl_add_u32 v115, v9, 4, v2
    s_cmp_ge_u32 s3, 4
    s_cbranch_scc1 K2_AUX
    v_lshrrev_b32 v8, 5, v0
    v_add_u32 v8, s11, v8
    v_mul_u32_u24 v8, 625, v8
    v_add_u32 v8, 127, v8
    v_lshrrev_b32 v8, 7, v8
    v_bfe_u32 v7, v0, 2, 3
    v_add_u32 v8, v8, v7
    v_and_b32 v7, 3, v0
    v_mul_u32_u24 v8, 6, v8
    v_lshl_add_u32 v8, v7, 1, v8
    s_mov_b32 s34, 60000
    s_mov_b32 s35, 0x20000
    s_waitcnt lgkmcnt(0)
    s_mov_b32 s32, s18
    s_mov_b32 s33, s19
    buffer_load_ushort v114, v8, s[32:35], 0 offen
    s_branch K2_AUXD
K2_AUX:
    s_cmp_ge_u32 s3, 6
    s_cbranch_scc1 K2_AUXD
    s_lshl_b32 s12, s3, 10
    s_add_u32 m0, s12, 6656
    v_lshlrev_b32 v8, 4, v0
    s_mov_b32 s13, 16904192
    s_lshl_b32 s12, s5, 4
    s_lshr_b32 exec_hi, -1, s12
    s_waitcnt lgkmcnt(0)
    s_mov_b32 s24, s22
    s_mov_b32 s25, s23
    buffer_load_dwordx4 v8, s[24:27], s13 offen lds
    s_mov_b64 exec, -1
K2_AUXD:
    s_waitcnt lgkmcnt(0)
    s_mov_b32 s24, s22
    s_mov_b32 s25, s23
    buffer_load_dword v99, v108, s[24:27], s8 offen
    s_lshl1_add_u32 s15, s4, s5
    s_mul_i32 s15, s15, 640
    s_add_u32 s59, s11, s4
    s_mul_i32 s59, s59, 625
    s_add_u32 s59, s59, 127
    s_lshr_b32 s59, s59, 7
    s_lshl1_add_u32 s59, s59, s5
    s_lshl_b32 s59, s59, 7
    s_add_u32 m0, s15, 512
    s_add_u32 s59, s59, 2621440
    v_mov_b32 v4, 0
    v_mov_b32 v5, 0
    v_mov_b32 v6, 0
    v_mov_b32 v7, 0
    v_mul_u32_u24 v72, 80, v0
    v_add_u32 v73, 81920, v72
    s_cmp_ge_u32 s3, 12
    ds_write_b128 v72, v[4:7] offset:20368
    ds_write_b128 v72, v[4:7] offset:20384
    ds_write_b32 v72, v4 offset:20400
    s_cbranch_scc1 K2_ZF1
    ds_write_b128 v73, v[4:7] offset:20368
    ds_write_b128 v73, v[4:7] offset:20384
    ds_write_b32 v73, v4 offset:20400
    s_branch K2_ZG1
K2_ZF1:
    v_lshlrev_b32 v75, 4, v0
    s_cmp_eq_u32 s3, 15
    ds_write_b128 v75, v[4:7] offset:896
    s_cbranch_scc1 K2_ZC1
    ds_write_b128 v75, v[4:7] offset:4992
    s_branch K2_ZG1
K2_PAD0:
    s_endpgm
K2_ZC1:
    v_lshlrev_b32 v11, 2, v0
    ds_write_b32 v11, v4 offset:8704
    ds_write_b32 v4, v4 offset:0
    v_mov_b32 v8, 0x4400000
    ds_write_b32 v4, v8 offset:4
    v_lshlrev_b32 v8, 3, v0
    s_mov_b32 exec_hi, 0xffff
    ds_write_b64 v8, v[10:11] offset:5120
    s_mov_b32 exec_hi, -1
    s_mul_i32 s12, s11, 625
    s_add_u32 s12, s12, 127
    v_bfe_u32 v9, v0, 1, 3
    v_bfe_u32 v8, v0, 4, 2
    v_lshl_add_u32 v127, v8, 1, v77
    v_mad_u32_u24 v8, v9, 3, v8
    v_and_or_b32 v8, v8, 7, 32
    v_mad_u32_u24 v126, v9, 10, v127
    v_lshl_add_u32 v8, v126, 3, v8
    v_mul_u32_u24 v125, 88, v9
    v_mad_u32_u24 v125, v126, 36, v125
    v_lshl_add_u32 v125, v8, 20, v125
    v_mul_u32_u24 v9, 625, v9
    v_add_u32 v9, s12, v9
    v_and_b32 v8, 0xffffff80, v9
    v_lshl_add_u32 v8, v127, 7, v8
    v_add_u32 v9, 497, v9
    v_cmp_le_u32 vcc, v8, v9
    v_lshlrev_b32 v8, 1, v8
    v_mov_b32 v126, 0x0a100500
    v_cndmask_b32 v124, v10, v8, vcc
K2_ZG1:
    v_mfma_f32_32x32x16_bf16 v[16:31], v[4:7], v[4:7], 0
    s_mul_i32 s12, s5, 1310720
    s_add_u32 s12, s12, 4096
    s_add_u32 s28, s22, s12
    s_addc_u32 s29, s23, 0
    s_and_b32 s29, s29, 0xffff
    s_bitset1_b32 s29, 31
    s_mov_b32 s30, 0x1000000
    s_mov_b32 s31, 0x00c00000
    s_mov_b32 s36, s20
    s_mov_b32 s37, s21
    s_mov_b32 s38, 2620000
    s_mov_b32 s39, 0x20000
    s_mov_b32 s6, 0
    s_mov_b32 s7, 32
    s_mov_b32 s64, 1
    s_lshl_b32 s60, s4, 1
    s_mov_b32 s50, 0x05040100
    s_mov_b32 s51, 0x07060302
    s_mov_b32 s57, 0xbf803f80
    s_and_b32 s12, s2, 3
    s_lshl_b32 s55, s12, 6
    s_mul_i32 s12, s12, 0x40404040
    s_sub_u32 s55, 0xff, s55
    s_mul_i32 s61, s4, 171
    s_lshr_b32 s52, s61, 9
    s_bfe_u32 s61, s61, 0x30005
    s_lshl2_add_u32 s61, s5, s61
    s_mul_i32 s61, s61, 160
    s_add_u32 s61, s61, 17536
    s_mul_i32 s52, s52, 4
    s_lshl_b32 s52, 0x200000, s52
    v_mfma_f32_32x32x16_bf16 v[32:47], v[4:7], v[4:7], 0
    v_bfe_u32 v9, v0, 5, 1
    v_and_b32 v10, 31, v0
    v_lshlrev_b32 v1, 4, v9
    v_mul_u32_u24 v2, 80, v10
    v_add_u32 v2, v1, v2
    v_lshlrev_b32 v72, 2, v10
    v_lshl_add_u32 v71, v9, 9, v72
    v_lshl_add_u32 v72, s5, 8, v72
    v_bfe_u32 v3, v0, 2, 2
    v_lshl_add_u32 v3, v9, 3, v3
    s_movk_i32 s13, 80
    v_mad_u32_u24 v3, v3, s13, 8
    v_bfe_u32 v10, v0, 4, 1
    v_lshl_add_u32 v3, v10, 5, v3
    v_and_b32 v10, 3, v0
    v_lshl_add_u32 v3, v10, 3, v3
    v_mov_b32 v112, 4294723968
    v_and_b32 v64, 62, v0
    v_bfe_u32 v9, v0, 1, 3
    s_movk_i32 s13, 896
    v_mov_b32 v65, 14076
    v_mad_u32_u24 v65, v9, s13, v65
    v_bfe_u32 v10, v0, 4, 2
    v_and_b32 v66, 1, v0
    v_lshl_add_u32 v66, v10, 1, v66
    v_sub_u32 v67, v66, v9
    v_lshlrev_b32 v66, 3, v66
    v_and_b32 v10, 14, v0
    v_mov_b32 v68, 0x30003
    v_lshlrev_b32 v68, v10, v68
    v_lshlrev_b32 v64, 2, v64
    v_mov_b32 v69, 4
    s_mov_b32 exec_lo, 0xcccc0000
    s_mov_b32 exec_hi, 0xcccc0000
    v_mov_b32 v3, 0x100000
    s_mov_b32 exec_lo, 0x22220000
    s_mov_b32 exec_hi, 0x22220000
    v_subrev_u32 v3, 48, v3
    s_mov_b64 exec, -1
    s_cmp_ge_u32 s3, 16
    s_cbranch_scc1 K2_LD0
    buffer_load_dwordx4 v[80:83], v113, s[24:27], s56 offen
    s_movk_i32 exec_hi, 0xff
    buffer_load_dwordx4 v115, s[24:27], s59 offen lds
    s_mov_b64 exec, -1
K2_LD0:
    v_mov_b32 v11, s12
    v_lshlrev_b32 v77, 4, v77
    v_or_b32 v78, 8, v77
    s_cmp_ge_u32 s3, 4
    s_cbranch_scc1 K2_PDD
    v_lshlrev_b32 v8, 1, v0
    s_mov_b32 exec_lo, 0x77777
    s_mov_b32 exec_hi, 0x77777
    s_waitcnt vmcnt(3)
    ds_write_b16 v8, v114 offset:8
    s_mov_b64 exec, -1
K2_PDD:
    s_cmp_lt_u32 s3, 16
    s_waitcnt lgkmcnt(0)
    s_barrier
    s_cbranch_scc1 K2_LD1
    buffer_load_dwordx4 v[80:83], v113, s[24:27], s56 offen
    s_movk_i32 exec_hi, 0xff
    buffer_load_dwordx4 v115, s[24:27], s59 offen lds
    s_mov_b64 exec, -1
K2_LD1:
    s_waitcnt vmcnt(2)
    v_mov_b32_dpp v9, v99 quad_perm:[0,0,2,2] row_mask:0xf bank_mask:0xf
    v_xor_b32_dpp v10, v99, v11 quad_perm:[1,1,3,3] row_mask:0xf bank_mask:0xf
    v_bfe_u32 v96, v9, v77, 8
    v_bfe_u32 v97, v9, v78, 8
    v_cmp_ne_u32 s[42:43], 0, v97
    v_cmp_ne_u32 s[40:41], 0, v96
    s_nop 0
    v_cndmask_b32 v8, -2.0, v113, s[42:43]
    buffer_load_dwordx4 v[84:87], v8, s[24:27], s56 offen offset:128
    v_and_b32 v60, 0xf8, v96
    v_lshlrev_b32_sdwa v96, 2, v96 dst_sel:BYTE_0 dst_unused:UNUSED_PAD src0_sel:DWORD src1_sel:DWORD
    v_and_b32 v61, 0xf8, v97
    v_lshlrev_b32_sdwa v97, 2, v97 dst_sel:BYTE_0 dst_unused:UNUSED_PAD src0_sel:DWORD src1_sel:DWORD
    s_mov_b64 exec, s[40:41]
    ds_add_rtn_u32 v100, v60, v69 offset:12544
    v_add_u32 v116, v96, v96
    ds_read_b64 v[116:117], v116 offset:0
    s_mov_b64 exec, s[42:43]
    ds_add_rtn_u32 v101, v61, v69 offset:12544
    v_add_u32 v118, v97, v97
    ds_read_b64 v[118:119], v118 offset:0
    s_mov_b64 exec, -1
    v_bfe_u32 v98, v10, v77, 8
    v_bfe_u32 v99, v10, v78, 8
    v_add_u32 v9, -1, v98
    v_add_u32 v10, -1, v99
    v_cmp_gt_u32 s[44:45], 61, v9
    v_cmp_gt_u32 s[46:47], 61, v10
    v_cmp_eq_u32 s[48:49], s55, v99
    v_cndmask_b32 v11, -2.0, v113, s[44:45]
    s_or_b64 s[62:63], s[44:45], s[46:47]
    buffer_load_dwordx4 v[88:91], v11, s[24:27], s58 offen
    s_cbranch_scc0 K2_NOOV
K2_COMMON:
    v_and_b32 v62, 0xf8, v98
    v_lshlrev_b32_sdwa v98, 2, v98 dst_sel:BYTE_0 dst_unused:UNUSED_PAD src0_sel:DWORD src1_sel:DWORD
    v_and_b32 v63, 0xf8, v99
    v_lshlrev_b32_sdwa v99, 2, v99 dst_sel:BYTE_0 dst_unused:UNUSED_PAD src0_sel:DWORD src1_sel:DWORD
    s_mov_b64 exec, s[44:45]
    ds_add_rtn_u32 v102, v62, v69 offset:12544
    v_add_u32 v120, v98, v98
    ds_read_b64 v[120:121], v120 offset:0
    s_mov_b64 exec, s[46:47]
    ds_add_rtn_u32 v103, v63, v69 offset:12544
    v_add_u32 v122, v99, v99
    ds_read_b64 v[122:123], v122 offset:0
    s_branch K2_NOOV
K2_PAD1:
    s_endpgm
K2_NOOV:
    s_mov_b64 exec, s[48:49]
    ds_write_b32 v4, v112 offset:0
    s_mov_b64 exec, -1
    s_bfe_u32 s12, s4, 0x10001
    s_xor_b32 s12, s12, s4
    s_cmp_eq_u64 s[46:47], 0
    s_waitcnt lgkmcnt(0)
    s_barrier
    ds_read_b32 v9, v64 offset:12544
    ds_read_b32 v8, v4 offset:0
    s_cbranch_scc1 K2_LD3
    s_cmp_eq_u32 s55, 0
    s_cbranch_scc1 K2_LD3
    buffer_load_dwordx4 v[92:95], v113, s[24:27], s58 offen offset:128
    s_waitcnt vmcnt(0)
K2_LD3:
    s_waitcnt lgkmcnt(1)
    v_mov_b32 v10, v9
    s_cmp_eq_u64 s[62:63], 0
    s_waitcnt lgkmcnt(0)
    v_permlane16_swap_b32 v9, v10
    v_add_u32 v11, v9, v10
    v_add_u32 v10, v9, v10
    v_subrev_u32_dpp v65, v9, v65 quad_perm:[0,1,2,3] row_mask:0xa bank_mask:0xf
    v_readfirstlane_b32 s53, v8
    v_permlane32_swap_b32 v11, v10
    s_mov_b32 exec_lo, 0
    v_sub_u32 v65, v65, v11
    s_mov_b32 exec_lo, -1
    ds_bpermute_b32 v60, v60, v65
    ds_bpermute_b32 v61, v61, v65
    v_add_u32 v70, v11, v10
    ds_bpermute_b32 v64, v66, v70
    v_cmp_lt_u32 vcc, s13, v70
    s_cbranch_scc1 K2_NOOV2
    ds_bpermute_b32 v62, v62, v65
    ds_bpermute_b32 v63, v63, v65
K2_NOOV2:
    s_cbranch_vccnz K2_OVERFLOW
    s_waitcnt vmcnt(3) lgkmcnt(0)
    v_sub_u32 v100, v60, v100
    s_mov_b64 exec, s[40:41]
    ds_write_b16_d16_hi v100, v83
    s_mov_b64 exec, -1
    v_perm_b32 v108, v82, v116, s50
    v_perm_b32 v109, v82, v116, s51
    v_perm_b32 v110, v83, v117, s50
    v_dot2_f32_bf16 v108, v108, s57, 0
    v_dot2_f32_bf16 v109, v109, s57, 0
    v_dot2_f32_bf16 v110, v110, s57, 0
    v_mov_b32 v83, 0
    v_mad_u32_u24 v104, v100, 20, v112
    v_and_b32 v100, 0x1c, v96
    v_cvt_pk_bf16_f32 v117, v108, v109
    v_cvt_pk_bf16_f32 v116, v110, 1.0
    v_dot2_f32_bf16 v108, v116, v116, -1.0
    v_dot2_f32_bf16 v108, v117, v117, v108
    v_add_u32 v100, v100, v104
    s_nop 0
    s_mov_b64 exec, s[40:41]
    v_cvt_pk_bf16_f32 v82, v108, 0
    ds_write_b128 v104, v[80:83]
    ds_write2_b32 v100, v116, v117 offset0:2 offset1:7
    s_mov_b64 exec, -1
    s_cmp_eq_u32 s64, 1
    s_cbranch_scc0 K2_KEEP
    v_sub_u32 v11, v64, v70
    v_lshl_add_u32 v11, v11, 1, v67
    v_cmp_lt_i32 vcc, 0, v11
    s_cmp_eq_u32 s3, 15
    s_nop 0
    v_and_b32 v11, vcc_lo, v68
    v_and_b32 v68, vcc_hi, v68
    v_bcnt_u32_b32 v11, v11, 0
    v_bcnt_u32_b32 v11, v68, v11
    v_cmp_eq_u32 vcc, s12, v11
    s_ff1_i32_b32 s60, vcc_lo
    s_cbranch_scc1 K2_TABW
K2_KEEP:
    v_readlane_b32 s12, v70, s60
    s_mul_i32 s13, s60, 448
    s_sub_u32 s12, 896, s12
    s_andn2_b32 s14, s12, 127
    s_add_u32 s14, s14, s13
    v_add_u32 v1, s14, v1
    s_and_b32 s9, s12, 127
    s_waitcnt vmcnt(1)
    v_sub_u32 v101, v61, v101
    s_mov_b64 exec, s[42:43]
    ds_write_b16_d16_hi v101, v87
    s_mov_b64 exec, -1
    s_cmp_lt_u32 s3, 8
    s_cbranch_scc1 K2_B3
    s_cmp_eq_u64 s[62:63], 0
    s_cbranch_scc1 K2_B3W
    s_waitcnt vmcnt(0)
    v_sub_u32 v102, v62, v102
    s_mov_b64 exec, s[44:45]
    ds_write_b16_d16_hi v102, v91
    s_mov_b64 exec, -1
    v_sub_u32 v103, v63, v103
    s_mov_b64 exec, s[46:47]
    ds_write_b16_d16_hi v103, v95
    s_mov_b64 exec, -1
K2_B3W:
    s_cmp_ge_u32 s3, 8
    s_waitcnt vmcnt(1) lgkmcnt(0)
    s_barrier
K2_B3:
    v_perm_b32 v108, v86, v118, s50
    v_perm_b32 v109, v86, v118, s51
    v_perm_b32 v110, v87, v119, s50
    v_dot2_f32_bf16 v108, v108, s57, 0
    v_dot2_f32_bf16 v109, v109, s57, 0
    v_dot2_f32_bf16 v110, v110, s57, 0
    v_mov_b32 v87, 0
    v_mad_u32_u24 v105, v101, 20, v112
    v_and_b32 v101, 0x1c, v97
    v_cvt_pk_bf16_f32 v119, v108, v109
    v_cvt_pk_bf16_f32 v118, v110, 1.0
    v_dot2_f32_bf16 v108, v118, v118, -1.0
    v_dot2_f32_bf16 v108, v119, v119, v108
    v_add_u32 v101, v101, v105
    s_nop 0
    s_mov_b64 exec, s[42:43]
    v_cvt_pk_bf16_f32 v86, v108, 0
    ds_write_b128 v105, v[84:87]
    ds_write2_b32 v101, v118, v119 offset0:2 offset1:7
    s_mov_b64 exec, -1
    s_cmp_eq_u64 s[62:63], 0
    s_cbranch_scc1 K2_SC0
    s_cmp_ge_u32 s3, 8
    s_cbranch_scc1 K2_OVD
    s_waitcnt vmcnt(0)
    v_sub_u32 v102, v62, v102
    s_mov_b64 exec, s[44:45]
    ds_write_b16_d16_hi v102, v91
    s_mov_b64 exec, -1
    v_sub_u32 v103, v63, v103
    s_mov_b64 exec, s[46:47]
    ds_write_b16_d16_hi v103, v95
    s_mov_b64 exec, -1
K2_OVD:
    v_perm_b32 v108, v90, v120, s50
    v_perm_b32 v109, v90, v120, s51
    v_perm_b32 v110, v91, v121, s50
    v_dot2_f32_bf16 v108, v108, s57, 0
    v_dot2_f32_bf16 v109, v109, s57, 0
    v_dot2_f32_bf16 v110, v110, s57, 0
    v_mov_b32 v91, 0
    v_mad_u32_u24 v106, v102, 20, v112
    v_and_b32 v102, 0x1c, v98
    v_cvt_pk_bf16_f32 v121, v108, v109
    v_cvt_pk_bf16_f32 v120, v110, 1.0
    v_dot2_f32_bf16 v108, v120, v120, -1.0
    v_dot2_f32_bf16 v108, v121, v121, v108
    v_add_u32 v102, v102, v106
    s_nop 0
    s_mov_b64 exec, s[44:45]
    v_cvt_pk_bf16_f32 v90, v108, 0
    ds_write_b128 v106, v[88:91]
    ds_write2_b32 v102, v120, v121 offset0:2 offset1:7
    s_mov_b64 exec, -1
    s_cmp_eq_u64 s[46:47], 0
    s_cbranch_scc1 K2_SC0
    v_perm_b32 v108, v94, v122, s50
    v_perm_b32 v109, v94, v122, s51
    v_perm_b32 v110, v95, v123, s50
    v_dot2_f32_bf16 v108, v108, s57, 0
    v_dot2_f32_bf16 v109, v109, s57, 0
    v_dot2_f32_bf16 v110, v110, s57, 0
    v_mov_b32 v95, 0
    v_mad_u32_u24 v107, v103, 20, v112
    v_and_b32 v103, 0x1c, v99
    v_cvt_pk_bf16_f32 v123, v108, v109
    v_cvt_pk_bf16_f32 v122, v110, 1.0
    v_dot2_f32_bf16 v108, v122, v122, -1.0
    v_dot2_f32_bf16 v108, v123, v123, v108
    v_add_u32 v103, v103, v107
    s_nop 0
    s_mov_b64 exec, s[46:47]
    v_cvt_pk_bf16_f32 v94, v108, 0
    ds_write_b128 v107, v[92:95]
    ds_write2_b32 v103, v122, v123 offset0:2 offset1:7
    s_mov_b64 exec, -1
    s_branch K2_SC0
K2_PAD2:
    s_endpgm
K2_SC0:
    s_setprio 3
    s_waitcnt vmcnt(1) lgkmcnt(0)
    s_barrier
    ds_read_b128 v[60:63], v1 offset:13280
    ds_read_b128 v[56:59], v1 offset:13248
    ds_read_b128 v[52:55], v1 offset:13216
    ds_read_b128 v[48:51], v1 offset:13184
    s_cmpk_eq_u32 s12, 896
    s_cbranch_scc1 K2_GO
    s_cmpk_ge_u32 s9, 96
    s_waitcnt lgkmcnt(3)
    buffer_load_dword v60, v60, s[28:31], 0 offen
    buffer_load_dword v61, v61, s[28:31], 0 offen
    buffer_load_dword v62, v62, s[28:31], 0 offen
    buffer_load_dword v63, v63, s[28:31], 0 offen
    s_cbranch_scc1 K2_GO
    s_cmpk_ge_u32 s9, 64
    s_waitcnt lgkmcnt(2)
    buffer_load_dword v56, v56, s[28:31], 0 offen
    buffer_load_dword v57, v57, s[28:31], 0 offen
    buffer_load_dword v58, v58, s[28:31], 0 offen
    buffer_load_dword v59, v59, s[28:31], 0 offen
    s_cbranch_scc1 K2_GO
    s_cmpk_ge_u32 s9, 32
    s_waitcnt lgkmcnt(1)
    buffer_load_dword v52, v52, s[28:31], 0 offen
    buffer_load_dword v53, v53, s[28:31], 0 offen
    buffer_load_dword v54, v54, s[28:31], 0 offen
    buffer_load_dword v55, v55, s[28:31], 0 offen
    s_cbranch_scc1 K2_GO
    s_waitcnt lgkmcnt(0)
    buffer_load_dword v48, v48, s[28:31], 0 offen
    buffer_load_dword v49, v49, s[28:31], 0 offen
    buffer_load_dword v50, v50, s[28:31], 0 offen
    buffer_load_dword v51, v51, s[28:31], 0 offen
K2_GO:
    s_mul_i32 s14, s14, 20
    v_add_u32 v2, s14, v2
    v_add_u32 v3, s14, v3
    s_lshr_b32 s13, s12, 2
    s_bfm_b32 exec_lo, s13, 0
    s_mov_b32 exec_hi, 0
    ds_write_b128 v2, v[4:7] offset:20352
    s_mov_b32 exec_lo, -1
    v_mov_b32 v4, 0x3f80
    s_mov_b64 exec, -1
    v_mov_b32 v6, 56797
    s_and_b32 s9, s13, 2
    s_or_b32 s9, s9, 12
    s_lshr_b32 s13, s12, 3
    s_and_b32 s9, s9, s13
    s_lshr_b32 s13, s12, 7
    s_sub_u32 s54, 7, s13
    s_cmp_eq_u32 s64, 1
    s_cbranch_scc0 K2_NOH
    s_lshr_b32 s4, s60, 1
    s_lshl1_add_u32 s15, s4, s5
    s_mul_i32 s15, s15, 640
    v_add_u32 v9, s15, v71
    v_lshlrev_b32 v10, 1, v72
    ds_read2_b32 v[126:127], v9 offset0:96 offset1:128
    ds_read2_b32 v[124:125], v9 offset0:32 offset1:64
    s_mov_b32 exec_hi, 0
    ds_read_b64 v[124:125], v10 offset:10752
    ds_read_b64 v[12:13], v10 offset:11008
    ds_read_b32 v126, v72 offset:11776
    ds_read_b32 v14, v72 offset:11904
    s_mov_b64 exec, -1
    s_add_u32 s59, s11, s4
    s_mul_i32 s59, s59, 625
    s_add_u32 s59, s59, 127
    s_and_b32 s58, s59, 127
    s_lshr_b32 s59, s59, 7
    s_lshl1_add_u32 s59, s59, s5
    s_lshl_b32 s59, s59, 7
    s_add_u32 m0, s15, 512
    s_mul_i32 s14, s4, 48
    s_lshl_b32 s13, s5, 6
    s_add_u32 s14, s14, s13
    v_add_u32 v8, s14, v0
    v_and_b32 v8, 0x70, v8
    v_xor_b32 v8, v8, v115
    s_mov_b32 s32, s16
    s_mov_b32 s33, s17
    s_mov_b32 s34, 2560000
    s_mov_b32 s35, 0x20000
    s_cmp_ge_u32 s58, 15
    s_cselect_b32 s58, 15, 12
    s_mul_i32 s56, s4, 17920
    s_add_u32 s61, s61, s56
    s_add_u32 s56, s56, 27872
    s_mov_b32 s15, 0xffff0000
    s_waitcnt lgkmcnt(0)
    v_and_b32 v15, s15, v127
    v_lshlrev_b32 v127, 16, v127
    s_mov_b32 exec_lo, 0
    v_and_b32 v12, s15, v124
    v_lshlrev_b32 v124, 16, v124
    v_and_b32 v13, s15, v125
    v_lshlrev_b32 v125, 16, v125
    v_and_b32 v14, s15, v126
    v_lshlrev_b32 v126, 16, v126
    s_mov_b64 exec, -1
K2_NOH:
    s_cmp_ge_u32 s3, 8
    s_cbranch_scc1 K2_B4
    s_waitcnt lgkmcnt(0)
    s_barrier
    s_branch K2_B4
K2_TABW:
    s_mov_b32 s13, 0x20251a15
    v_perm_b32 v11, s13, v126, v11
    v_lshl_add_u32 v10, v11, 3, v66
    v_and_b32 v11, 7, v11
    v_lshl_add_u32 v125, v11, 2, v125
    s_movk_i32 exec_hi, 0x5555
    ds_write_b64 v10, v[124:125] offset:12800
    s_mov_b64 exec, -1
    s_branch K2_KEEP
K2_EMPTY:
    s_cmp_eq_u32 s64, 0
    s_cbranch_scc1 K2_HD3
    s_movk_i32 exec_hi, 0xff
    buffer_load_dwordx4 v8, s[32:35], s59 offen lds
    s_mov_b64 exec, -1
    v_mov_b32 v8, 0x10000
K2_HD3:
    s_branch K2_LOOP_DONE
.p2align 12
K2_PAD3:
    s_endpgm
K2_B4:
    ds_read_b128 v[112:115], v2 offset:20352
    ds_read_b128 v[64:67], v1 offset:13312
    ds_read_b128 v[68:71], v1 offset:13344
    ds_read_b128 v[72:75], v1 offset:13376
    ds_read_b128 v[76:79], v1 offset:13408
    v_bfe_u32 v9, v0, 2, 3
    v_bfe_u32 v10, v0, 5, 1
    v_and_b32 v11, 3, v0
    s_movk_i32 s13, 80
    v_mad_u32_u24 v7, v10, 36, v9
    v_mul_u32_u24 v10, 6, v10
    v_mad_u32_u24 v9, v9, 15, v10
    v_lshl_add_u32 v10, v11, 2, s61
    v_lshl_add_u32 v11, v11, 2, s56
    v_mad_u32_u24 v7, v7, s13, v10
    v_mad_u32_u24 v9, v9, s13, v11
    s_and_b32 s45, s3, 3
    s_lshl_b32 s45, s45, 2
    s_and_b32 s46, s3, 14
    v_lshlrev_b32 v10, s46, 1
    v_lshlrev_b32 v11, s45, 1
    s_cmp_eq_u32 s54, 0
    s_cbranch_scc1 K2_EMPTY
    s_cmp_ge_u32 s9, 8
    s_waitcnt vmcnt(0) lgkmcnt(4)
    v_lshlrev_b32 v88, 16, v56
    v_lshlrev_b32 v89, 16, v57
    v_lshlrev_b32 v90, 16, v58
    v_lshlrev_b32 v91, 16, v59
    v_lshlrev_b32 v92, 16, v60
    v_lshlrev_b32 v93, 16, v61
    v_lshlrev_b32 v94, 16, v62
    v_lshlrev_b32 v95, 16, v63
    s_cbranch_scc1 K2_F1
    v_lshlrev_b32 v80, 16, v48
    v_lshlrev_b32 v81, 16, v49
    v_lshlrev_b32 v82, 16, v50
    v_lshlrev_b32 v83, 16, v51
    v_lshlrev_b32 v84, 16, v52
    v_lshlrev_b32 v85, 16, v53
    v_lshlrev_b32 v86, 16, v54
    v_lshlrev_b32 v87, 16, v55
K2_F1:
    v_mfma_f32_32x32x16_bf16 v[48:63], v[112:115], v[12:15], v[48:63]
    ds_read_b64_tr_b16 v[116:117], v3 offset:20360
    ds_read_b64_tr_b16 v[118:119], v3 offset:20680
    ds_read_b64_tr_b16 v[120:121], v3 offset:21640
    ds_read_b64_tr_b16 v[122:123], v3 offset:21960
    v_mfma_f32_32x32x16_bf16 v[80:95], v[112:115], v[124:127], v[80:95]
    ds_read_b128 v[112:115], v2 offset:22912
    s_sub_u32 s54, s54, 1
    s_cmp_ge_u32 s9, 8
    s_nop 4
    s_cbranch_scc1 K2_FU
    s_cmp_eq_u32 s9, 6
    v_exp_f32 v102, v54
    v_exp_f32 v103, v55
    v_exp_f32 v110, v86
    v_exp_f32 v111, v87
    s_cbranch_scc1 K2_FE0
    s_cmp_eq_u32 s9, 4
    v_exp_f32 v100, v52
    v_exp_f32 v101, v53
    v_exp_f32 v108, v84
    v_exp_f32 v109, v85
    s_cbranch_scc1 K2_FE0
    s_cmp_eq_u32 s9, 2
    v_exp_f32 v98, v50
    v_exp_f32 v99, v51
    v_exp_f32 v106, v82
    v_exp_f32 v107, v83
    s_cbranch_scc1 K2_FE0
    v_exp_f32 v96, v48
    v_exp_f32 v97, v49
    v_exp_f32 v104, v80
    v_exp_f32 v105, v81
K2_FE0:
    s_nop 1
    v_mfma_f32_32x32x8_bf16 v[96:111], v[4:5], v[4:5], v[96:111]
    s_nop 7
    s_cmp_eq_u32 s54, 0
    s_waitcnt lgkmcnt(0)
    s_cbranch_scc1 K2_FS0
    buffer_load_dword v64, v64, s[28:31], 0 offen
    buffer_load_dword v65, v65, s[28:31], 0 offen
    buffer_load_dword v66, v66, s[28:31], 0 offen
    buffer_load_dword v67, v67, s[28:31], 0 offen
    buffer_load_dword v68, v68, s[28:31], 0 offen
    buffer_load_dword v69, v69, s[28:31], 0 offen
    buffer_load_dword v70, v70, s[28:31], 0 offen
    buffer_load_dword v71, v71, s[28:31], 0 offen
    buffer_load_dword v72, v72, s[28:31], 0 offen
    buffer_load_dword v73, v73, s[28:31], 0 offen
    buffer_load_dword v74, v74, s[28:31], 0 offen
    buffer_load_dword v75, v75, s[28:31], 0 offen
    buffer_load_dword v76, v76, s[28:31], 0 offen
    buffer_load_dword v77, v77, s[28:31], 0 offen
    buffer_load_dword v78, v78, s[28:31], 0 offen
    buffer_load_dword v79, v79, s[28:31], 0 offen
K2_FS0:
    s_cmp_eq_u32 s64, 0
    s_cbranch_scc1 K2_HD1
    s_movk_i32 exec_hi, 0xff
    buffer_load_dwordx4 v8, s[32:35], s59 offen lds
    s_mov_b64 exec, -1
    v_mov_b32 v8, 0x10000
K2_HD1:
    s_cmp_eq_u32 s9, 6
    v_rcp_f32 v102, v102
    v_rcp_f32 v103, v103
    v_rcp_f32 v110, v110
    v_rcp_f32 v111, v111
    v_pk_mul_f32 v[54:55], v[54:55], v[102:103]
    v_pk_mul_f32 v[86:87], v[86:87], v[110:111]
    s_cbranch_scc1 K2_FM0
    s_cmp_eq_u32 s9, 4
    v_rcp_f32 v100, v100
    v_rcp_f32 v101, v101
    v_rcp_f32 v108, v108
    v_rcp_f32 v109, v109
    v_pk_mul_f32 v[52:53], v[52:53], v[100:101]
    v_pk_mul_f32 v[84:85], v[84:85], v[108:109]
    s_cbranch_scc1 K2_FM0
    s_cmp_eq_u32 s9, 2
    v_rcp_f32 v98, v98
    v_rcp_f32 v99, v99
    v_rcp_f32 v106, v106
    v_rcp_f32 v107, v107
    v_pk_mul_f32 v[50:51], v[50:51], v[98:99]
    v_pk_mul_f32 v[82:83], v[82:83], v[106:107]
    s_cbranch_scc1 K2_FM0
    v_rcp_f32 v96, v96
    v_rcp_f32 v97, v97
    v_rcp_f32 v104, v104
    v_rcp_f32 v105, v105
    v_pk_mul_f32 v[48:49], v[48:49], v[96:97]
    v_pk_mul_f32 v[80:81], v[80:81], v[104:105]
K2_FM0:
    s_waitcnt lgkmcnt(0)
    v_smfmac_f32_32x32x32_bf16 v[32:47], v[116:119], v[48:55], v6
    v_smfmac_f32_32x32x32_bf16 v[16:31], v[116:119], v[80:87], v6
    s_branch K2_FU
K2_PAD4:
    s_endpgm
K2_FU:
    s_cmp_eq_u32 s9, 14
    v_exp_f32 v102, v62
    v_exp_f32 v103, v63
    v_exp_f32 v110, v94
    v_exp_f32 v111, v95
    s_cbranch_scc1 K2_FE1
    s_cmp_eq_u32 s9, 12
    v_exp_f32 v100, v60
    v_exp_f32 v101, v61
    v_exp_f32 v108, v92
    v_exp_f32 v109, v93
    s_cbranch_scc1 K2_FE1
    s_cmp_eq_u32 s9, 10
    v_exp_f32 v98, v58
    v_exp_f32 v99, v59
    v_exp_f32 v106, v90
    v_exp_f32 v107, v91
    s_cbranch_scc1 K2_FE1
    v_exp_f32 v96, v56
    v_exp_f32 v97, v57
    v_exp_f32 v104, v88
    v_exp_f32 v105, v89
K2_FE1:
    s_nop 1
    v_mfma_f32_32x32x8_bf16 v[96:111], v[4:5], v[4:5], v[96:111]
    s_nop 7
    s_cmp_lt_u32 s9, 8
    s_nop 0
    s_cbranch_scc1 K2_FR
    s_cmp_eq_u32 s54, 0
    s_waitcnt lgkmcnt(0)
    s_cbranch_scc1 K2_FS1
    buffer_load_dword v64, v64, s[28:31], 0 offen
    buffer_load_dword v65, v65, s[28:31], 0 offen
    buffer_load_dword v66, v66, s[28:31], 0 offen
    buffer_load_dword v67, v67, s[28:31], 0 offen
    buffer_load_dword v68, v68, s[28:31], 0 offen
    buffer_load_dword v69, v69, s[28:31], 0 offen
    buffer_load_dword v70, v70, s[28:31], 0 offen
    buffer_load_dword v71, v71, s[28:31], 0 offen
    buffer_load_dword v72, v72, s[28:31], 0 offen
    buffer_load_dword v73, v73, s[28:31], 0 offen
    buffer_load_dword v74, v74, s[28:31], 0 offen
    buffer_load_dword v75, v75, s[28:31], 0 offen
    buffer_load_dword v76, v76, s[28:31], 0 offen
    buffer_load_dword v77, v77, s[28:31], 0 offen
    buffer_load_dword v78, v78, s[28:31], 0 offen
    buffer_load_dword v79, v79, s[28:31], 0 offen
K2_FS1:
    s_cmp_eq_u32 s64, 0
    s_cbranch_scc1 K2_HD2
    s_movk_i32 exec_hi, 0xff
    buffer_load_dwordx4 v8, s[32:35], s59 offen lds
    s_mov_b64 exec, -1
    v_mov_b32 v8, 0x10000
K2_HD2:
K2_FR:
    s_cmp_eq_u32 s9, 14
    v_rcp_f32 v102, v102
    v_rcp_f32 v103, v103
    v_rcp_f32 v110, v110
    v_rcp_f32 v111, v111
    v_pk_mul_f32 v[62:63], v[62:63], v[102:103]
    v_pk_mul_f32 v[94:95], v[94:95], v[110:111]
    s_cbranch_scc1 K2_FM1
    s_cmp_eq_u32 s9, 12
    v_rcp_f32 v100, v100
    v_rcp_f32 v101, v101
    v_rcp_f32 v108, v108
    v_rcp_f32 v109, v109
    v_pk_mul_f32 v[60:61], v[60:61], v[100:101]
    v_pk_mul_f32 v[92:93], v[92:93], v[108:109]
    s_cbranch_scc1 K2_FM1
    s_cmp_eq_u32 s9, 10
    v_rcp_f32 v98, v98
    v_rcp_f32 v99, v99
    v_rcp_f32 v106, v106
    v_rcp_f32 v107, v107
    v_pk_mul_f32 v[58:59], v[58:59], v[98:99]
    v_pk_mul_f32 v[90:91], v[90:91], v[106:107]
    s_cbranch_scc1 K2_FM1
    v_rcp_f32 v96, v96
    v_rcp_f32 v97, v97
    v_rcp_f32 v104, v104
    v_rcp_f32 v105, v105
    v_pk_mul_f32 v[56:57], v[56:57], v[96:97]
    v_pk_mul_f32 v[88:89], v[88:89], v[104:105]
K2_FM1:
    s_waitcnt lgkmcnt(0)
    v_smfmac_f32_32x32x32_bf16 v[32:47], v[120:123], v[56:63], v6
    ds_read_b128 v[48:51], v1 offset:13440
    ds_read_b128 v[52:55], v1 offset:13472
    ds_read_b128 v[56:59], v1 offset:13504
    ds_read_b128 v[60:63], v1 offset:13536
    v_smfmac_f32_32x32x32_bf16 v[16:31], v[120:123], v[88:95], v6
    s_cmp_lt_u32 s54, 2
    s_waitcnt lgkmcnt(0)
    s_cbranch_scc1 K2_FX
    buffer_load_dword v48, v48, s[28:31], 0 offen
    buffer_load_dword v49, v49, s[28:31], 0 offen
    buffer_load_dword v50, v50, s[28:31], 0 offen
    buffer_load_dword v51, v51, s[28:31], 0 offen
    buffer_load_dword v52, v52, s[28:31], 0 offen
    buffer_load_dword v53, v53, s[28:31], 0 offen
    buffer_load_dword v54, v54, s[28:31], 0 offen
    buffer_load_dword v55, v55, s[28:31], 0 offen
    buffer_load_dword v56, v56, s[28:31], 0 offen
    buffer_load_dword v57, v57, s[28:31], 0 offen
    buffer_load_dword v58, v58, s[28:31], 0 offen
    buffer_load_dword v59, v59, s[28:31], 0 offen
    buffer_load_dword v60, v60, s[28:31], 0 offen
    buffer_load_dword v61, v61, s[28:31], 0 offen
    buffer_load_dword v62, v62, s[28:31], 0 offen
    buffer_load_dword v63, v63, s[28:31], 0 offen
    s_branch K2_XB
K2_FX:
    s_cmp_eq_u32 s54, 0
    s_cbranch_scc1 K2_LOOP_DONE
    s_branch K2_XB
K2_PAD5:
    s_endpgm
K2_TB:
    s_cmp_lt_u32 s54, s70
    s_cbranch_scc1 K2_XB
    s_waitcnt vmcnt(16) lgkmcnt(0)
K2_GB:
    v_lshlrev_b32 v80, 16, v64
    v_lshlrev_b32 v81, 16, v65
    v_lshlrev_b32 v82, 16, v66
    v_lshlrev_b32 v83, 16, v67
    v_lshlrev_b32 v84, 16, v68
    v_lshlrev_b32 v85, 16, v69
    v_lshlrev_b32 v86, 16, v70
    v_lshlrev_b32 v87, 16, v71
    v_lshlrev_b32 v88, 16, v72
    v_lshlrev_b32 v89, 16, v73
    v_lshlrev_b32 v90, 16, v74
    v_lshlrev_b32 v91, 16, v75
    v_lshlrev_b32 v92, 16, v76
    v_lshlrev_b32 v93, 16, v77
    v_lshlrev_b32 v94, 16, v78
    v_lshlrev_b32 v95, 16, v79
    v_mfma_f32_32x32x16_bf16 v[64:79], v[112:115], v[12:15], v[64:79]
    ds_read_b64_tr_b16 v[116:117], v3 offset:22920
    ds_read_b64_tr_b16 v[118:119], v3 offset:23240
    ds_read_b64_tr_b16 v[120:121], v3 offset:24200
    ds_read_b64_tr_b16 v[122:123], v3 offset:24520
    v_mfma_f32_32x32x16_bf16 v[80:95], v[112:115], v[124:127], v[80:95]
    ds_read_b128 v[112:115], v2 offset:25472
    s_sub_u32 s54, s54, 1
    s_nop 4
    v_exp_f32 v96, v64
    v_exp_f32 v97, v65
    v_exp_f32 v98, v66
    v_exp_f32 v99, v67
    v_exp_f32 v100, v68
    v_exp_f32 v101, v69
    v_exp_f32 v102, v70
    v_exp_f32 v103, v71
    v_exp_f32 v104, v72
    v_exp_f32 v105, v73
    v_exp_f32 v106, v74
    v_exp_f32 v107, v75
    v_exp_f32 v108, v76
    v_exp_f32 v109, v77
    v_exp_f32 v110, v78
    v_exp_f32 v111, v79
    s_nop 1
    v_mfma_f32_32x32x8_bf16 v[96:111], v[4:5], v[4:5], v[96:111]
    s_nop 7
    s_nop 3
    v_rcp_f32 v96, v96
    v_rcp_f32 v97, v97
    v_rcp_f32 v98, v98
    v_rcp_f32 v99, v99
    v_rcp_f32 v100, v100
    v_rcp_f32 v101, v101
    v_rcp_f32 v102, v102
    v_rcp_f32 v103, v103
    v_rcp_f32 v104, v104
    v_rcp_f32 v105, v105
    v_rcp_f32 v106, v106
    v_rcp_f32 v107, v107
    v_rcp_f32 v108, v108
    v_rcp_f32 v109, v109
    v_rcp_f32 v110, v110
    v_rcp_f32 v111, v111
    v_pk_mul_f32 v[64:65], v[64:65], v[96:97]
    v_pk_mul_f32 v[66:67], v[66:67], v[98:99]
    v_pk_mul_f32 v[68:69], v[68:69], v[100:101]
    v_pk_mul_f32 v[70:71], v[70:71], v[102:103]
    v_pk_mul_f32 v[72:73], v[72:73], v[104:105]
    v_pk_mul_f32 v[74:75], v[74:75], v[106:107]
    v_pk_mul_f32 v[76:77], v[76:77], v[108:109]
    v_pk_mul_f32 v[78:79], v[78:79], v[110:111]
    s_waitcnt lgkmcnt(1)
    v_exp_f32 v96, v80
    v_exp_f32 v97, v81
    v_smfmac_f32_32x32x32_bf16 v[32:47], v[116:119], v[64:71], v6
    v_exp_f32 v98, v82
    v_exp_f32 v99, v83
    v_exp_f32 v100, v84
    v_exp_f32 v101, v85
    v_smfmac_f32_32x32x32_bf16 v[32:47], v[120:123], v[72:79], v6
    ds_read_b128 v[64:67], v1 offset:13568
    ds_read_b128 v[68:71], v1 offset:13600
    ds_read_b128 v[72:75], v1 offset:13632
    ds_read_b128 v[76:79], v1 offset:13664
    v_exp_f32 v102, v86
    v_exp_f32 v103, v87
    v_exp_f32 v104, v88
    v_exp_f32 v105, v89
    v_exp_f32 v106, v90
    v_exp_f32 v107, v91
    v_exp_f32 v108, v92
    v_exp_f32 v109, v93
    v_exp_f32 v110, v94
    v_exp_f32 v111, v95
    s_nop 1
    v_mfma_f32_32x32x8_bf16 v[96:111], v[4:5], v[4:5], v[96:111]
    s_cmp_lt_u32 s54, 2
    s_waitcnt lgkmcnt(0)
    s_cbranch_scc1 K2_D2BS
    buffer_load_dword v64, v64, s[28:31], 0 offen
    buffer_load_dword v65, v65, s[28:31], 0 offen
    buffer_load_dword v66, v66, s[28:31], 0 offen
    buffer_load_dword v67, v67, s[28:31], 0 offen
    buffer_load_dword v68, v68, s[28:31], 0 offen
    buffer_load_dword v69, v69, s[28:31], 0 offen
    buffer_load_dword v70, v70, s[28:31], 0 offen
    buffer_load_dword v71, v71, s[28:31], 0 offen
    buffer_load_dword v72, v72, s[28:31], 0 offen
    buffer_load_dword v73, v73, s[28:31], 0 offen
    buffer_load_dword v74, v74, s[28:31], 0 offen
    buffer_load_dword v75, v75, s[28:31], 0 offen
    buffer_load_dword v76, v76, s[28:31], 0 offen
    buffer_load_dword v77, v77, s[28:31], 0 offen
    buffer_load_dword v78, v78, s[28:31], 0 offen
    buffer_load_dword v79, v79, s[28:31], 0 offen
K2_D2B:
    v_rcp_f32 v96, v96
    v_rcp_f32 v97, v97
    v_rcp_f32 v98, v98
    v_rcp_f32 v99, v99
    v_rcp_f32 v100, v100
    v_rcp_f32 v101, v101
    v_rcp_f32 v102, v102
    v_rcp_f32 v103, v103
    v_rcp_f32 v104, v104
    v_rcp_f32 v105, v105
    v_rcp_f32 v106, v106
    v_rcp_f32 v107, v107
    v_rcp_f32 v108, v108
    v_rcp_f32 v109, v109
    v_rcp_f32 v110, v110
    v_rcp_f32 v111, v111
    v_pk_mul_f32 v[80:81], v[80:81], v[96:97]
    v_pk_mul_f32 v[82:83], v[82:83], v[98:99]
    v_pk_mul_f32 v[84:85], v[84:85], v[100:101]
    v_pk_mul_f32 v[86:87], v[86:87], v[102:103]
    v_pk_mul_f32 v[88:89], v[88:89], v[104:105]
    v_pk_mul_f32 v[90:91], v[90:91], v[106:107]
    v_pk_mul_f32 v[92:93], v[92:93], v[108:109]
    v_pk_mul_f32 v[94:95], v[94:95], v[110:111]
    v_add_u32 v1, 256, v1
    v_add_u32 v2, 5120, v2
    v_add_u32 v3, 5120, v3
    s_cmp_eq_u32 s54, 0
    v_smfmac_f32_32x32x32_bf16 v[16:31], v[116:119], v[80:87], v6
    v_smfmac_f32_32x32x32_bf16 v[16:31], v[120:123], v[88:95], v6
    s_cbranch_scc1 K2_LOOP_DONE
K2_TA:
    s_cmp_lt_u32 s54, s70
    s_cbranch_scc1 K2_XA
    s_waitcnt vmcnt(16) lgkmcnt(0)
K2_GA:
    v_lshlrev_b32 v80, 16, v48
    v_lshlrev_b32 v81, 16, v49
    v_lshlrev_b32 v82, 16, v50
    v_lshlrev_b32 v83, 16, v51
    v_lshlrev_b32 v84, 16, v52
    v_lshlrev_b32 v85, 16, v53
    v_lshlrev_b32 v86, 16, v54
    v_lshlrev_b32 v87, 16, v55
    v_lshlrev_b32 v88, 16, v56
    v_lshlrev_b32 v89, 16, v57
    v_lshlrev_b32 v90, 16, v58
    v_lshlrev_b32 v91, 16, v59
    v_lshlrev_b32 v92, 16, v60
    v_lshlrev_b32 v93, 16, v61
    v_lshlrev_b32 v94, 16, v62
    v_lshlrev_b32 v95, 16, v63
    v_mfma_f32_32x32x16_bf16 v[48:63], v[112:115], v[12:15], v[48:63]
    ds_read_b64_tr_b16 v[116:117], v3 offset:20360
    ds_read_b64_tr_b16 v[118:119], v3 offset:20680
    ds_read_b64_tr_b16 v[120:121], v3 offset:21640
    ds_read_b64_tr_b16 v[122:123], v3 offset:21960
    v_mfma_f32_32x32x16_bf16 v[80:95], v[112:115], v[124:127], v[80:95]
    ds_read_b128 v[112:115], v2 offset:22912
    s_sub_u32 s54, s54, 1
    s_nop 4
    v_exp_f32 v96, v48
    v_exp_f32 v97, v49
    v_exp_f32 v98, v50
    v_exp_f32 v99, v51
    v_exp_f32 v100, v52
    v_exp_f32 v101, v53
    v_exp_f32 v102, v54
    v_exp_f32 v103, v55
    v_exp_f32 v104, v56
    v_exp_f32 v105, v57
    v_exp_f32 v106, v58
    v_exp_f32 v107, v59
    v_exp_f32 v108, v60
    v_exp_f32 v109, v61
    v_exp_f32 v110, v62
    v_exp_f32 v111, v63
    s_nop 1
    v_mfma_f32_32x32x8_bf16 v[96:111], v[4:5], v[4:5], v[96:111]
    s_nop 7
    s_nop 3
    v_rcp_f32 v96, v96
    v_rcp_f32 v97, v97
    v_rcp_f32 v98, v98
    v_rcp_f32 v99, v99
    v_rcp_f32 v100, v100
    v_rcp_f32 v101, v101
    v_rcp_f32 v102, v102
    v_rcp_f32 v103, v103
    v_rcp_f32 v104, v104
    v_rcp_f32 v105, v105
    v_rcp_f32 v106, v106
    v_rcp_f32 v107, v107
    v_rcp_f32 v108, v108
    v_rcp_f32 v109, v109
    v_rcp_f32 v110, v110
    v_rcp_f32 v111, v111
    v_pk_mul_f32 v[48:49], v[48:49], v[96:97]
    v_pk_mul_f32 v[50:51], v[50:51], v[98:99]
    v_pk_mul_f32 v[52:53], v[52:53], v[100:101]
    v_pk_mul_f32 v[54:55], v[54:55], v[102:103]
    v_pk_mul_f32 v[56:57], v[56:57], v[104:105]
    v_pk_mul_f32 v[58:59], v[58:59], v[106:107]
    v_pk_mul_f32 v[60:61], v[60:61], v[108:109]
    v_pk_mul_f32 v[62:63], v[62:63], v[110:111]
    s_waitcnt lgkmcnt(1)
    v_exp_f32 v96, v80
    v_exp_f32 v97, v81
    v_smfmac_f32_32x32x32_bf16 v[32:47], v[116:119], v[48:55], v6
    v_exp_f32 v98, v82
    v_exp_f32 v99, v83
    v_exp_f32 v100, v84
    v_exp_f32 v101, v85
    v_smfmac_f32_32x32x32_bf16 v[32:47], v[120:123], v[56:63], v6
    ds_read_b128 v[48:51], v1 offset:13440
    ds_read_b128 v[52:55], v1 offset:13472
    ds_read_b128 v[56:59], v1 offset:13504
    ds_read_b128 v[60:63], v1 offset:13536
    v_exp_f32 v102, v86
    v_exp_f32 v103, v87
    v_exp_f32 v104, v88
    v_exp_f32 v105, v89
    v_exp_f32 v106, v90
    v_exp_f32 v107, v91
    v_exp_f32 v108, v92
    v_exp_f32 v109, v93
    v_exp_f32 v110, v94
    v_exp_f32 v111, v95
    s_nop 1
    v_mfma_f32_32x32x8_bf16 v[96:111], v[4:5], v[4:5], v[96:111]
    s_cmp_lt_u32 s54, 2
    s_waitcnt lgkmcnt(0)
    s_cbranch_scc1 K2_D2AS
    buffer_load_dword v48, v48, s[28:31], 0 offen
    buffer_load_dword v49, v49, s[28:31], 0 offen
    buffer_load_dword v50, v50, s[28:31], 0 offen
    buffer_load_dword v51, v51, s[28:31], 0 offen
    buffer_load_dword v52, v52, s[28:31], 0 offen
    buffer_load_dword v53, v53, s[28:31], 0 offen
    buffer_load_dword v54, v54, s[28:31], 0 offen
    buffer_load_dword v55, v55, s[28:31], 0 offen
    buffer_load_dword v56, v56, s[28:31], 0 offen
    buffer_load_dword v57, v57, s[28:31], 0 offen
    buffer_load_dword v58, v58, s[28:31], 0 offen
    buffer_load_dword v59, v59, s[28:31], 0 offen
    buffer_load_dword v60, v60, s[28:31], 0 offen
    buffer_load_dword v61, v61, s[28:31], 0 offen
    buffer_load_dword v62, v62, s[28:31], 0 offen
    buffer_load_dword v63, v63, s[28:31], 0 offen
K2_D2A:
    v_rcp_f32 v96, v96
    v_rcp_f32 v97, v97
    v_rcp_f32 v98, v98
    v_rcp_f32 v99, v99
    v_rcp_f32 v100, v100
    v_rcp_f32 v101, v101
    v_rcp_f32 v102, v102
    v_rcp_f32 v103, v103
    v_rcp_f32 v104, v104
    v_rcp_f32 v105, v105
    v_rcp_f32 v106, v106
    v_rcp_f32 v107, v107
    v_rcp_f32 v108, v108
    v_rcp_f32 v109, v109
    v_rcp_f32 v110, v110
    v_rcp_f32 v111, v111
    v_pk_mul_f32 v[80:81], v[80:81], v[96:97]
    v_pk_mul_f32 v[82:83], v[82:83], v[98:99]
    v_pk_mul_f32 v[84:85], v[84:85], v[100:101]
    v_pk_mul_f32 v[86:87], v[86:87], v[102:103]
    v_pk_mul_f32 v[88:89], v[88:89], v[104:105]
    v_pk_mul_f32 v[90:91], v[90:91], v[106:107]
    v_pk_mul_f32 v[92:93], v[92:93], v[108:109]
    v_pk_mul_f32 v[94:95], v[94:95], v[110:111]
    s_cmp_eq_u32 s54, 0
    v_smfmac_f32_32x32x32_bf16 v[16:31], v[116:119], v[80:87], v6
    v_smfmac_f32_32x32x32_bf16 v[16:31], v[120:123], v[88:95], v6
    s_cbranch_scc0 K2_TB
K2_LOOP_DONE:
    s_waitcnt vmcnt(0)
    s_mov_b32 exec_lo, s64
    s_mov_b32 exec_hi, 0
    s_mov_b32 s64, 0
    ds_add_u32 v5, v8 offset:4
    s_mov_b64 exec, -1
    s_cmp_eq_u32 s53, 0
    s_cbranch_scc1 K2_EPI
    s_add_u32 s6, s6, s7
    s_branch K2_NEXT
K2_PAD6:
    s_endpgm
K2_XB:
    s_setprio 3
    s_movk_i32 s70, 5
    s_cmp_ge_u32 s54, 5
    s_cbranch_scc1 K2_YB
    s_setprio 2
    s_movk_i32 s70, 3
    s_cmp_ge_u32 s54, 3
    s_cbranch_scc1 K2_YB
    s_setprio 1
    s_movk_i32 s70, 2
    s_cmp_ge_u32 s54, 2
    s_cbranch_scc1 K2_YB
    s_setprio 0
    s_movk_i32 s70, 2
K2_YB:
    s_waitcnt vmcnt(16) lgkmcnt(0)
    s_cmp_ge_u32 s54, 2
    s_cbranch_scc1 K2_ZB
    s_waitcnt vmcnt(0)
K2_ZB:
    s_mov_b32 exec_lo, s64
    s_mov_b32 exec_hi, 0
    s_mov_b32 s64, 0
    ds_add_u32 v5, v8 offset:4
    s_mov_b64 exec, -1
    s_branch K2_GB
K2_D2BS:
    s_nop 7
    s_branch K2_D2B
K2_XA:
    s_setprio 3
    s_movk_i32 s70, 5
    s_cmp_ge_u32 s54, 5
    s_cbranch_scc1 K2_YA
    s_setprio 2
    s_movk_i32 s70, 3
    s_cmp_ge_u32 s54, 3
    s_cbranch_scc1 K2_YA
    s_setprio 1
    s_movk_i32 s70, 2
    s_cmp_ge_u32 s54, 2
    s_cbranch_scc1 K2_YA
    s_setprio 0
    s_movk_i32 s70, 2
K2_YA:
    s_waitcnt vmcnt(16) lgkmcnt(0)
    s_cmp_ge_u32 s54, 2
    s_cbranch_scc1 K2_ZA
    s_waitcnt vmcnt(0)
K2_ZA:
    s_branch K2_GA
K2_D2AS:
    s_nop 7
    s_branch K2_D2A
K2_EPI:
    s_setprio 3
    s_mov_b64 exec, 1
    ds_add_rtn_u64 v[10:11], v5, v[10:11] offset:0
    s_mov_b64 exec, -1
    v_mov_b32 v12, s52
    v_cvt_pk_bf16_f32 v17, v17, v33
    ds_write_b32 v7, v17 offset:4320
    v_cvt_pk_bf16_f32 v19, v19, v35
    ds_write_b32 v7, v19 offset:5760
    s_mov_b32 exec_lo, 0
    v_cvt_pk_bf16_f32 v27, v27, v43
    ds_write_b32 v7, v27 offset:0
    s_mov_b64 exec, 1
    ds_add_u32 v5, v12 offset:4
    s_mov_b64 exec, -1
    v_cvt_pk_bf16_f32 v16, v16, v32
    v_cvt_pk_bf16_f32 v18, v18, v34
    v_cvt_pk_bf16_f32 v20, v20, v36
    v_cvt_pk_bf16_f32 v21, v21, v37
    v_cvt_pk_bf16_f32 v22, v22, v38
    v_cvt_pk_bf16_f32 v23, v23, v39
    v_cvt_pk_bf16_f32 v24, v24, v40
    v_cvt_pk_bf16_f32 v25, v25, v41
    v_cvt_pk_bf16_f32 v26, v26, v42
    s_lshr_b32 s47, s46, 1
    s_add_u32 s47, s47, 16
    v_lshlrev_b32 v12, s47, 1
    v_and_b32 v13, 15, v0
    v_bfe_u32 v6, v0, 4, 2
    s_waitcnt lgkmcnt(4)
    v_readfirstlane_b32 s14, v10
    v_readfirstlane_b32 s12, v11
    s_bitcmp1_b32 s14, s46
    s_cselect_b32 s48, 0, 64
    v_add_u32 v9, s48, v9
    s_lshr_b32 s14, s12, s45
    s_and_b32 s49, s14, 3
    s_cmp_ge_u32 s49, 1
    ds_write_b32 v9, v16 offset:720
    ds_write_b32 v9, v18 offset:960
    ds_write_b32 v9, v20 offset:320
    ds_write_b32 v9, v21 offset:400
    ds_write_b32 v9, v22 offset:560
    ds_write_b32 v9, v23 offset:640
    s_mov_b32 exec_hi, 0
    ds_write_b32 v9, v24 offset:1280
    ds_write_b32 v9, v25 offset:1360
    s_mov_b32 exec_lo, 0
    s_mov_b32 exec_hi, -1
    ds_write_b32 v9, v26
    s_mov_b64 exec, 1
    ds_xor_rtn_b32 v10, v5, v12 offset:0
    s_mov_b64 exec, -1
    s_setprio 0
    s_cbranch_scc1 K2_EPI_P
    s_setprio 1
    s_lshr_b32 s15, s45, 1
    s_add_u32 s55, s15, s49
    v_and_b32 v7, 63, v0
    v_lshlrev_b32 v7, 4, v7
    s_lshl_b32 s14, s45, 12
    s_add_u32 s14, s14, 16777216
    s_add_u32 s15, s14, 4096
    buffer_load_dwordx4 v[48:51], v7, s[24:27], s14 offen offset:0
    buffer_load_dwordx4 v[52:55], v7, s[24:27], s14 offen offset:1024
    buffer_load_dwordx4 v[56:59], v7, s[24:27], s14 offen offset:2048
    buffer_load_dwordx4 v[60:63], v7, s[24:27], s14 offen offset:3072
    buffer_load_dwordx4 v[80:83], v7, s[24:27], s15 offen offset:0
    buffer_load_dwordx4 v[84:87], v7, s[24:27], s15 offen offset:1024
    buffer_load_dwordx4 v[88:91], v7, s[24:27], s15 offen offset:2048
    buffer_load_dwordx4 v[92:95], v7, s[24:27], s15 offen offset:3072
    s_add_u32 s14, s14, 8192
    s_add_u32 s15, s15, 8192
    buffer_load_dwordx4 v[64:67], v7, s[24:27], s14 offen offset:0
    buffer_load_dwordx4 v[68:71], v7, s[24:27], s14 offen offset:1024
    buffer_load_dwordx4 v[72:75], v7, s[24:27], s14 offen offset:2048
    buffer_load_dwordx4 v[76:79], v7, s[24:27], s14 offen offset:3072
    buffer_load_dwordx4 v[96:99], v7, s[24:27], s15 offen offset:0
    buffer_load_dwordx4 v[100:103], v7, s[24:27], s15 offen offset:1024
    buffer_load_dwordx4 v[104:107], v7, s[24:27], s15 offen offset:2048
    buffer_load_dwordx4 v[108:111], v7, s[24:27], s15 offen offset:3072
K2_EPI_P:
    s_mov_b32 s44, 0xbf31ecbe
    s_cmp_lg_u32 s48, 0
    s_cbranch_scc1 K2_EPI_Q
    s_lshl_b32 s14, s5, 7
    v_lshl_add_u32 v9, v6, 4, s14
    v_mad_u32_u24 v8, v6, 15, v13
    v_mul_u32_u24 v8, 80, v8
    v_add_u32 v8, s56, v8
    v_xor_b32 v11, 0x80, v9
    ds_read_b128 v[16:19], v9 offset:12288
    ds_read_b128 v[32:35], v8 offset:320
    ds_read_b128 v[20:23], v9 offset:12352
    ds_read_b128 v[36:39], v8 offset:5120
    ds_read_b128 v[24:27], v11 offset:12288
    ds_read_b128 v[28:31], v11 offset:12352
    v_mul_u32_u24 v7, 11, v13
    v_lshrrev_b32 v7, 5, v7
    ds_read_b128 v[40:43], v8 offset:384
    ds_read_b128 v[44:47], v8 offset:5184
    v_add_u32 v7, v7, v13
    s_lshl_b32 s14, s4, 6
    v_lshl_add_u32 v7, v7, 1, s14
    ds_read_u16 v7, v7 offset:8
    v_lshlrev_b32 v11, 1, v13
    s_waitcnt lgkmcnt(9)
    v_readfirstlane_b32 s14, v10
    s_bitcmp1_b32 s14, s47
    s_cbranch_scc1 K2_EPI_P3
K2_EPI_P1:
    ds_read_b32 v10, v5 offset:0
    s_waitcnt lgkmcnt(0)
    v_readfirstlane_b32 s14, v10
    s_bitcmp1_b32 s14, s47
    s_cbranch_scc1 K2_EPI_P1
K2_EPI_P2:
    ds_read_b128 v[40:43], v8 offset:384
    ds_read_b128 v[44:47], v8 offset:5184
    s_waitcnt lgkmcnt(0)
K2_EPI_P3:
    s_lshr_b32 s14, s59, 8
    s_mul_i32 s14, s14, 6
    s_add_u32 s14, s14, 2560000
    s_waitcnt lgkmcnt(7)
    v_mfma_f32_16x16x32_bf16 v[112:115], v[16:19], v[32:35], 0
    s_waitcnt lgkmcnt(5)
    v_mfma_f32_16x16x32_bf16 v[112:115], v[20:23], v[36:39], v[112:115]
    s_waitcnt lgkmcnt(2)
    v_mfma_f32_16x16x32_bf16 v[112:115], v[24:27], v[40:43], v[112:115]
    s_waitcnt lgkmcnt(1)
    v_mfma_f32_16x16x32_bf16 v[112:115], v[28:31], v[44:47], v[112:115]
    s_bfm_b64 exec, s58, 0
    s_waitcnt vmcnt(0) lgkmcnt(0)
    v_lshlrev_b32 v7, 16, v7
    s_nop 4
    v_fma_f32 v112, v112, s44, v7
    v_cvt_pk_bf16_f32 v112, v112, v112
    buffer_store_short v112, v11, s[36:39], s14 offen sc1
    s_mov_b64 exec, -1
    s_cmp_lt_u32 s49, 1
    s_cbranch_scc1 K2_EPI_N
K2_EPI_X:
    s_endpgm
.p2align 12
K2_PAD7:
    s_endpgm
K2_EPI_Q:
    s_cmp_ge_u32 s49, 1
    s_cbranch_scc1 K2_EPI_X
K2_EPI_N:
    v_lshlrev_b32 v8, 3, v13
    ds_read_b64 v[120:121], v8 offset:12800
    ds_read_b64 v[122:123], v8 offset:12928
    ds_read_b64 v[124:125], v8 offset:13056
    s_bitcmp1_b32 s12, 20
    s_cbranch_scc1 K2_EPI_WD
K2_EPI_W:
    ds_read_b32 v11, v5 offset:4
    s_waitcnt lgkmcnt(0)
    v_readfirstlane_b32 s12, v11
    s_bitcmp1_b32 s12, 20
    s_cbranch_scc1 K2_EPI_WD
    s_sleep 1
    s_branch K2_EPI_W
K2_EPI_WD:
    v_lshlrev_b32 v7, 4, v6
    v_mul_u32_u24 v8, 80, v6
    v_add_u32 v8, 20416, v8
    s_lshl_b32 s13, s45, 4
    v_add_u32 v9, s13, v7
    s_and_b32 s15, s13, 64
    s_lshr_b32 s14, s45, 3
    s_mul_i32 s14, s14, 640
    v_mov_b32 v10, s15
    s_mov_b32 s46, 0xbfb82aef
    s_mov_b32 s47, s46
    s_mov_b32 s45, s44
    s_cmp_eq_u32 s48, 0
    s_mov_b32 s48, 0x3f805879
    s_mov_b32 s49, s48
    s_waitcnt lgkmcnt(0)
    v_mad_u32_u16 v1, v121, 40, v8
    v_xor_b32_sdwa v121, v121, v7 dst_sel:DWORD dst_unused:UNUSED_PAD src0_sel:WORD_1 src1_sel:DWORD
    v_xor_b32 v12, 64, v121
    ds_read_b128 v[16:19], v121 offset:0
    ds_read_b128 v[20:23], v12 offset:0
    ds_read_b128 v[24:27], v121 offset:640
    ds_read_b128 v[28:31], v12 offset:640
    v_mad_u32_u16 v2, v123, 40, v8
    v_xor_b32_sdwa v123, v123, v7 dst_sel:DWORD dst_unused:UNUSED_PAD src0_sel:WORD_1 src1_sel:DWORD
    v_xor_b32 v14, 64, v123
    v_mad_u32_u16 v3, v125, 40, v8
    v_xor_b32_sdwa v125, v125, v7 dst_sel:DWORD dst_unused:UNUSED_PAD src0_sel:WORD_1 src1_sel:DWORD
    v_xor_b32 v15, 64, v125
    v_add_u32 v120, v120, v9
    v_add_u32 v122, v122, v9
    v_add_u32 v124, v124, v9
    s_cbranch_scc1 K2_EPI_V
    s_waitcnt vmcnt(0)
K2_EPI_V:
    s_waitcnt lgkmcnt(3)
    v_mfma_f32_16x16x32_bf16 v[32:35], v[48:51], v[16:19], 0
    v_mfma_f32_16x16x32_bf16 v[36:39], v[64:67], v[16:19], 0
    ds_read_b128 v[16:19], v123 offset:0
    s_waitcnt lgkmcnt(3)
    v_mfma_f32_16x16x32_bf16 v[32:35], v[52:55], v[20:23], v[32:35]
    v_mfma_f32_16x16x32_bf16 v[36:39], v[68:71], v[20:23], v[36:39]
    ds_read_b128 v[20:23], v14 offset:0
    s_waitcnt lgkmcnt(3)
    v_mfma_f32_16x16x32_bf16 v[32:35], v[56:59], v[24:27], v[32:35]
    v_mfma_f32_16x16x32_bf16 v[36:39], v[72:75], v[24:27], v[36:39]
    ds_read_b128 v[24:27], v123 offset:640
    s_waitcnt lgkmcnt(3)
    v_mfma_f32_16x16x32_bf16 v[32:35], v[60:63], v[28:31], v[32:35]
    v_mfma_f32_16x16x32_bf16 v[36:39], v[76:79], v[28:31], v[36:39]
    ds_read_b128 v[28:31], v14 offset:640
    s_waitcnt lgkmcnt(3)
    v_mfma_f32_16x16x32_bf16 v[40:43], v[48:51], v[16:19], 0
    v_mfma_f32_16x16x32_bf16 v[44:47], v[64:67], v[16:19], 0
    ds_read_b128 v[16:19], v125 offset:0
    s_waitcnt lgkmcnt(3)
    v_mfma_f32_16x16x32_bf16 v[40:43], v[52:55], v[20:23], v[40:43]
    v_mfma_f32_16x16x32_bf16 v[44:47], v[68:71], v[20:23], v[44:47]
    ds_read_b128 v[20:23], v15 offset:0
    s_waitcnt lgkmcnt(3)
    v_mfma_f32_16x16x32_bf16 v[40:43], v[56:59], v[24:27], v[40:43]
    v_mfma_f32_16x16x32_bf16 v[44:47], v[72:75], v[24:27], v[44:47]
    ds_read_b128 v[24:27], v125 offset:640
    s_waitcnt lgkmcnt(3)
    v_mfma_f32_16x16x32_bf16 v[40:43], v[60:63], v[28:31], v[40:43]
    v_mfma_f32_16x16x32_bf16 v[44:47], v[76:79], v[28:31], v[44:47]
    ds_read_b128 v[28:31], v15 offset:640
    s_waitcnt lgkmcnt(3)
    v_mfma_f32_16x16x32_bf16 v[112:115], v[48:51], v[16:19], 0
    v_mfma_f32_16x16x32_bf16 v[116:119], v[64:67], v[16:19], 0
    v_xad_u32 v11, v121, v10, s14
    ds_read_b128 v[16:19], v11
    s_waitcnt lgkmcnt(3)
    v_mfma_f32_16x16x32_bf16 v[112:115], v[52:55], v[20:23], v[112:115]
    v_mfma_f32_16x16x32_bf16 v[116:119], v[68:71], v[20:23], v[116:119]
    v_xad_u32 v11, v123, v10, s14
    ds_read_b128 v[20:23], v11
    s_waitcnt lgkmcnt(3)
    v_mfma_f32_16x16x32_bf16 v[112:115], v[56:59], v[24:27], v[112:115]
    v_mfma_f32_16x16x32_bf16 v[116:119], v[72:75], v[24:27], v[116:119]
    v_xad_u32 v11, v125, v10, s14
    ds_read_b128 v[24:27], v11
    s_waitcnt lgkmcnt(3)
    v_mfma_f32_16x16x32_bf16 v[112:115], v[60:63], v[28:31], v[112:115]
    v_mfma_f32_16x16x32_bf16 v[116:119], v[76:79], v[28:31], v[116:119]
    s_mov_b32 s13, 0xffff0000
    v_pk_mul_f32 v[32:33], v[32:33], s[46:47]
    v_pk_mul_f32 v[34:35], v[34:35], s[46:47]
    v_pk_mul_f32 v[36:37], v[36:37], s[46:47]
    v_pk_mul_f32 v[38:39], v[38:39], s[46:47]
    v_pk_mul_f32 v[40:41], v[40:41], s[46:47]
    v_pk_mul_f32 v[42:43], v[42:43], s[46:47]
    v_pk_mul_f32 v[44:45], v[44:45], s[46:47]
    v_pk_mul_f32 v[46:47], v[46:47], s[46:47]
    s_nop 1
    v_pk_mul_f32 v[112:113], v[112:113], s[46:47]
    v_pk_mul_f32 v[114:115], v[114:115], s[46:47]
    v_pk_mul_f32 v[116:117], v[116:117], s[46:47]
    v_pk_mul_f32 v[118:119], v[118:119], s[46:47]
    s_waitcnt lgkmcnt(2)
    v_lshlrev_b32 v56, 16, v16
    v_and_b32 v57, s13, v16
    v_lshlrev_b32 v58, 16, v17
    v_and_b32 v59, s13, v17
    v_lshlrev_b32 v60, 16, v18
    v_and_b32 v61, s13, v18
    v_lshlrev_b32 v62, 16, v19
    v_and_b32 v63, s13, v19
    s_waitcnt lgkmcnt(1)
    v_lshlrev_b32 v64, 16, v20
    v_and_b32 v65, s13, v20
    v_lshlrev_b32 v66, 16, v21
    v_and_b32 v67, s13, v21
    v_lshlrev_b32 v68, 16, v22
    v_and_b32 v69, s13, v22
    v_lshlrev_b32 v70, 16, v23
    v_and_b32 v71, s13, v23
    s_waitcnt lgkmcnt(0)
    v_lshlrev_b32 v72, 16, v24
    v_and_b32 v73, s13, v24
    v_lshlrev_b32 v74, 16, v25
    v_and_b32 v75, s13, v25
    v_lshlrev_b32 v76, 16, v26
    v_and_b32 v77, s13, v26
    v_lshlrev_b32 v78, 16, v27
    v_and_b32 v79, s13, v27
    s_mov_b32 s13, 0x91000000
K2_EPI_D:
    s_and_b32 s14, s12, s13
    s_cbranch_scc1 K2_EPI_T0D
K2_EPI_T0:
    ds_read_b32 v11, v5 offset:4
    s_waitcnt lgkmcnt(0)
    v_readfirstlane_b32 s12, v11
    s_and_b32 s14, s12, s13
    s_cbranch_scc1 K2_EPI_T0D
    s_sleep 1
    s_branch K2_EPI_T0
K2_PAD8:
    s_endpgm
K2_EPI_T0D:
    s_bitcmp1_b32 s14, 31
    s_cbranch_scc1 K2_EPI_T2D
    s_bitcmp1_b32 s14, 28
    s_cbranch_scc1 K2_EPI_T1D
    ds_read_b128 v[16:19], v1 offset:0
    ds_read_b128 v[20:23], v1 offset:320
    ds_read_b128 v[24:27], v1 offset:640
    ds_read_b128 v[28:31], v1 offset:960
    s_waitcnt lgkmcnt(3)
    v_mfma_f32_16x16x32_bf16 v[32:35], v[80:83], v[16:19], v[32:35]
    v_mfma_f32_16x16x32_bf16 v[36:39], v[96:99], v[16:19], v[36:39]
    s_waitcnt lgkmcnt(2)
    v_mfma_f32_16x16x32_bf16 v[32:35], v[84:87], v[20:23], v[32:35]
    v_mfma_f32_16x16x32_bf16 v[36:39], v[100:103], v[20:23], v[36:39]
    s_waitcnt lgkmcnt(1)
    v_mfma_f32_16x16x32_bf16 v[32:35], v[88:91], v[24:27], v[32:35]
    v_mfma_f32_16x16x32_bf16 v[36:39], v[104:107], v[24:27], v[36:39]
    s_waitcnt lgkmcnt(0)
    v_mfma_f32_16x16x32_bf16 v[32:35], v[92:95], v[28:31], v[32:35]
    v_mfma_f32_16x16x32_bf16 v[36:39], v[108:111], v[28:31], v[36:39]
    s_nop 6
    v_pk_mul_f32 v[48:49], v[32:33], s[48:49]
    v_pk_mul_f32 v[50:51], v[34:35], s[48:49]
    v_pk_mul_f32 v[52:53], v[36:37], s[48:49]
    v_pk_mul_f32 v[54:55], v[38:39], s[48:49]
    v_exp_f32 v48, v48
    v_exp_f32 v49, v49
    v_exp_f32 v50, v50
    v_exp_f32 v51, v51
    v_exp_f32 v52, v52
    v_exp_f32 v53, v53
    v_exp_f32 v54, v54
    v_exp_f32 v55, v55
    v_pk_add_f32 v[48:49], v[48:49], 1.0 op_sel_hi:[1,0]
    v_pk_add_f32 v[50:51], v[50:51], 1.0 op_sel_hi:[1,0]
    v_pk_add_f32 v[52:53], v[52:53], 1.0 op_sel_hi:[1,0]
    v_pk_add_f32 v[54:55], v[54:55], 1.0 op_sel_hi:[1,0]
    v_rcp_f32 v48, v48
    v_rcp_f32 v49, v49
    v_rcp_f32 v50, v50
    v_rcp_f32 v51, v51
    v_rcp_f32 v52, v52
    v_rcp_f32 v53, v53
    v_rcp_f32 v54, v54
    v_rcp_f32 v55, v55
    v_pk_mul_f32 v[32:33], v[32:33], s[44:45]
    v_pk_mul_f32 v[34:35], v[34:35], s[44:45]
    v_pk_mul_f32 v[36:37], v[36:37], s[44:45]
    v_pk_mul_f32 v[38:39], v[38:39], s[44:45]
    v_pk_fma_f32 v[32:33], v[32:33], v[48:49], v[56:57]
    v_pk_fma_f32 v[34:35], v[34:35], v[50:51], v[58:59]
    v_pk_fma_f32 v[36:37], v[36:37], v[52:53], v[60:61]
    v_pk_fma_f32 v[38:39], v[38:39], v[54:55], v[62:63]
    v_cvt_pk_bf16_f32 v32, v32, v33
    v_cvt_pk_bf16_f32 v33, v34, v35
    v_cvt_pk_bf16_f32 v34, v36, v37
    v_cvt_pk_bf16_f32 v35, v38, v39
    buffer_store_dwordx4 v[32:35], v120, s[36:39], 0 offen sc1
    s_andn2_b32 s13, s13, 0x1000000
    s_cbranch_scc1 K2_EPI_D
    s_endpgm
K2_EPI_T1D:
    ds_read_b128 v[16:19], v2 offset:0
    ds_read_b128 v[20:23], v2 offset:320
    ds_read_b128 v[24:27], v2 offset:640
    ds_read_b128 v[28:31], v2 offset:960
    s_waitcnt lgkmcnt(3)
    v_mfma_f32_16x16x32_bf16 v[40:43], v[80:83], v[16:19], v[40:43]
    v_mfma_f32_16x16x32_bf16 v[44:47], v[96:99], v[16:19], v[44:47]
    s_waitcnt lgkmcnt(2)
    v_mfma_f32_16x16x32_bf16 v[40:43], v[84:87], v[20:23], v[40:43]
    v_mfma_f32_16x16x32_bf16 v[44:47], v[100:103], v[20:23], v[44:47]
    s_waitcnt lgkmcnt(1)
    v_mfma_f32_16x16x32_bf16 v[40:43], v[88:91], v[24:27], v[40:43]
    v_mfma_f32_16x16x32_bf16 v[44:47], v[104:107], v[24:27], v[44:47]
    s_waitcnt lgkmcnt(0)
    v_mfma_f32_16x16x32_bf16 v[40:43], v[92:95], v[28:31], v[40:43]
    v_mfma_f32_16x16x32_bf16 v[44:47], v[108:111], v[28:31], v[44:47]
    s_nop 6
    v_pk_mul_f32 v[48:49], v[40:41], s[48:49]
    v_pk_mul_f32 v[50:51], v[42:43], s[48:49]
    v_pk_mul_f32 v[52:53], v[44:45], s[48:49]
    v_pk_mul_f32 v[54:55], v[46:47], s[48:49]
    v_exp_f32 v48, v48
    v_exp_f32 v49, v49
    v_exp_f32 v50, v50
    v_exp_f32 v51, v51
    v_exp_f32 v52, v52
    v_exp_f32 v53, v53
    v_exp_f32 v54, v54
    v_exp_f32 v55, v55
    v_pk_add_f32 v[48:49], v[48:49], 1.0 op_sel_hi:[1,0]
    v_pk_add_f32 v[50:51], v[50:51], 1.0 op_sel_hi:[1,0]
    v_pk_add_f32 v[52:53], v[52:53], 1.0 op_sel_hi:[1,0]
    v_pk_add_f32 v[54:55], v[54:55], 1.0 op_sel_hi:[1,0]
    v_rcp_f32 v48, v48
    v_rcp_f32 v49, v49
    v_rcp_f32 v50, v50
    v_rcp_f32 v51, v51
    v_rcp_f32 v52, v52
    v_rcp_f32 v53, v53
    v_rcp_f32 v54, v54
    v_rcp_f32 v55, v55
    v_pk_mul_f32 v[40:41], v[40:41], s[44:45]
    v_pk_mul_f32 v[42:43], v[42:43], s[44:45]
    v_pk_mul_f32 v[44:45], v[44:45], s[44:45]
    v_pk_mul_f32 v[46:47], v[46:47], s[44:45]
    v_pk_fma_f32 v[40:41], v[40:41], v[48:49], v[64:65]
    v_pk_fma_f32 v[42:43], v[42:43], v[50:51], v[66:67]
    v_pk_fma_f32 v[44:45], v[44:45], v[52:53], v[68:69]
    v_pk_fma_f32 v[46:47], v[46:47], v[54:55], v[70:71]
    v_cvt_pk_bf16_f32 v40, v40, v41
    v_cvt_pk_bf16_f32 v41, v42, v43
    v_cvt_pk_bf16_f32 v42, v44, v45
    v_cvt_pk_bf16_f32 v43, v46, v47
    buffer_store_dwordx4 v[40:43], v122, s[36:39], 0 offen sc1
    s_andn2_b32 s13, s13, 0x10000000
    s_cbranch_scc1 K2_EPI_D
    s_endpgm
K2_PAD9:
    s_endpgm
K2_EPI_T2D:
    ds_read_b128 v[16:19], v3 offset:0
    ds_read_b128 v[20:23], v3 offset:320
    ds_read_b128 v[24:27], v3 offset:640
    ds_read_b128 v[28:31], v3 offset:960
    s_waitcnt lgkmcnt(3)
    v_mfma_f32_16x16x32_bf16 v[112:115], v[80:83], v[16:19], v[112:115]
    v_mfma_f32_16x16x32_bf16 v[116:119], v[96:99], v[16:19], v[116:119]
    s_waitcnt lgkmcnt(2)
    v_mfma_f32_16x16x32_bf16 v[112:115], v[84:87], v[20:23], v[112:115]
    v_mfma_f32_16x16x32_bf16 v[116:119], v[100:103], v[20:23], v[116:119]
    s_waitcnt lgkmcnt(1)
    v_mfma_f32_16x16x32_bf16 v[112:115], v[88:91], v[24:27], v[112:115]
    v_mfma_f32_16x16x32_bf16 v[116:119], v[104:107], v[24:27], v[116:119]
    s_waitcnt lgkmcnt(0)
    v_mfma_f32_16x16x32_bf16 v[112:115], v[92:95], v[28:31], v[112:115]
    v_mfma_f32_16x16x32_bf16 v[116:119], v[108:111], v[28:31], v[116:119]
    s_nop 6
    v_pk_mul_f32 v[48:49], v[112:113], s[48:49]
    v_pk_mul_f32 v[50:51], v[114:115], s[48:49]
    v_pk_mul_f32 v[52:53], v[116:117], s[48:49]
    v_pk_mul_f32 v[54:55], v[118:119], s[48:49]
    v_exp_f32 v48, v48
    v_exp_f32 v49, v49
    v_exp_f32 v50, v50
    v_exp_f32 v51, v51
    v_exp_f32 v52, v52
    v_exp_f32 v53, v53
    v_exp_f32 v54, v54
    v_exp_f32 v55, v55
    v_pk_add_f32 v[48:49], v[48:49], 1.0 op_sel_hi:[1,0]
    v_pk_add_f32 v[50:51], v[50:51], 1.0 op_sel_hi:[1,0]
    v_pk_add_f32 v[52:53], v[52:53], 1.0 op_sel_hi:[1,0]
    v_pk_add_f32 v[54:55], v[54:55], 1.0 op_sel_hi:[1,0]
    v_rcp_f32 v48, v48
    v_rcp_f32 v49, v49
    v_rcp_f32 v50, v50
    v_rcp_f32 v51, v51
    v_rcp_f32 v52, v52
    v_rcp_f32 v53, v53
    v_rcp_f32 v54, v54
    v_rcp_f32 v55, v55
    v_pk_mul_f32 v[112:113], v[112:113], s[44:45]
    v_pk_mul_f32 v[114:115], v[114:115], s[44:45]
    v_pk_mul_f32 v[116:117], v[116:117], s[44:45]
    v_pk_mul_f32 v[118:119], v[118:119], s[44:45]
    v_pk_fma_f32 v[112:113], v[112:113], v[48:49], v[72:73]
    v_pk_fma_f32 v[114:115], v[114:115], v[50:51], v[74:75]
    v_pk_fma_f32 v[116:117], v[116:117], v[52:53], v[76:77]
    v_pk_fma_f32 v[118:119], v[118:119], v[54:55], v[78:79]
    v_cvt_pk_bf16_f32 v112, v112, v113
    v_cvt_pk_bf16_f32 v113, v114, v115
    v_cvt_pk_bf16_f32 v114, v116, v117
    v_cvt_pk_bf16_f32 v115, v118, v119
    buffer_store_dwordx4 v[112:115], v124, s[36:39], 0 offen sc1
    s_andn2_b32 s13, s13, 0x80000000
    s_cbranch_scc1 K2_EPI_D
K2_EPI_Z:
K2_END:
    s_endpgm
K1_PREP:
    s_cmp_ge_u32 s56, 640
    s_cbranch_scc1 K1_TAIL
    v_lshrrev_b32 v7, 6, v0
    v_and_b32 v40, 63, v0
    s_sub_u32 s34, s2, 253
    v_readfirstlane_b32 s41, v7
    s_mul_i32 s35, s34, 10
    s_add_u32 s35, s35, s41
    v_and_b32 v41, 15, v40
    v_and_b32 v42, 12, v40
    v_add_u32 v41, v41, v42
    v_lshrrev_b32 v42, 4, v40
    v_lshlrev_b32 v43, 4, v40
    s_waitcnt lgkmcnt(0)
    s_mov_b32 s44, s30
    s_mov_b32 s45, s31
    s_mov_b32 s46, 65536
    s_mov_b32 s47, 0x20000
    s_add_u32 s52, s32, 16777216
    s_addc_u32 s53, s33, 0
    s_mov_b32 s54, 65536
    s_mov_b32 s55, 0x20000
    s_add_u32 s36, s35, 0
    s_lshr_b32 s38, s36, 3
    s_and_b32 s39, s36, 7
    s_lshr_b32 s40, s38, 1
    s_lshl_b32 s40, s40, 3
    s_and_b32 s48, s38, 1
    s_add_u32 s40, s40, s48
    s_lshl_b32 s40, s40, 3
    v_lshl_add_u32 v44, v41, 1, s40
    s_cmp_ge_u32 s39, 4
    s_cbranch_scc1 K1_PREP_M0
    s_lshl_b32 s48, s39, 13
    v_lshl_add_u32 v44, v42, 11, v44
    buffer_load_ushort v48, v44, s[44:47], s48 offen offset:0
    buffer_load_ushort v49, v44, s[44:47], s48 offen offset:256
    buffer_load_ushort v50, v44, s[44:47], s48 offen offset:512
    buffer_load_ushort v51, v44, s[44:47], s48 offen offset:768
    buffer_load_ushort v52, v44, s[44:47], s48 offen offset:1024
    buffer_load_ushort v53, v44, s[44:47], s48 offen offset:1280
    buffer_load_ushort v54, v44, s[44:47], s48 offen offset:1536
    buffer_load_ushort v55, v44, s[44:47], s48 offen offset:1792
    s_branch K1_PREP_N0
K1_PREP_M0:
    s_lshr_b32 s48, s39, 1
    s_lshl_b32 s48, s48, 14
    s_and_b32 s49, s39, 1
    s_lshl_b32 s49, s49, 12
    s_add_u32 s48, s48, s49
    s_add_u32 s49, s48, 8192
    v_lshl_add_u32 v44, v42, 10, v44
    buffer_load_ushort v48, v44, s[44:47], s48 offen offset:0
    buffer_load_ushort v49, v44, s[44:47], s49 offen offset:0
    buffer_load_ushort v50, v44, s[44:47], s48 offen offset:256
    buffer_load_ushort v51, v44, s[44:47], s49 offen offset:256
    buffer_load_ushort v52, v44, s[44:47], s48 offen offset:512
    buffer_load_ushort v53, v44, s[44:47], s49 offen offset:512
    buffer_load_ushort v54, v44, s[44:47], s48 offen offset:768
    buffer_load_ushort v55, v44, s[44:47], s49 offen offset:768
K1_PREP_N0:
    s_add_u32 s36, s35, 30
    s_lshr_b32 s38, s36, 3
    s_and_b32 s39, s36, 7
    s_lshr_b32 s40, s38, 1
    s_lshl_b32 s40, s40, 3
    s_and_b32 s48, s38, 1
    s_add_u32 s40, s40, s48
    s_lshl_b32 s40, s40, 3
    v_lshl_add_u32 v44, v41, 1, s40
    s_cmp_ge_u32 s39, 4
    s_cbranch_scc1 K1_PREP_M1
    s_lshl_b32 s48, s39, 13
    v_lshl_add_u32 v44, v42, 11, v44
    buffer_load_ushort v56, v44, s[44:47], s48 offen offset:0
    buffer_load_ushort v57, v44, s[44:47], s48 offen offset:256
    buffer_load_ushort v58, v44, s[44:47], s48 offen offset:512
    buffer_load_ushort v59, v44, s[44:47], s48 offen offset:768
    buffer_load_ushort v60, v44, s[44:47], s48 offen offset:1024
    buffer_load_ushort v61, v44, s[44:47], s48 offen offset:1280
    buffer_load_ushort v62, v44, s[44:47], s48 offen offset:1536
    buffer_load_ushort v63, v44, s[44:47], s48 offen offset:1792
    s_branch K1_PREP_N1
K1_PREP_M1:
    s_lshr_b32 s48, s39, 1
    s_lshl_b32 s48, s48, 14
    s_and_b32 s49, s39, 1
    s_lshl_b32 s49, s49, 12
    s_add_u32 s48, s48, s49
    s_add_u32 s49, s48, 8192
    v_lshl_add_u32 v44, v42, 10, v44
    buffer_load_ushort v56, v44, s[44:47], s48 offen offset:0
    buffer_load_ushort v57, v44, s[44:47], s49 offen offset:0
    buffer_load_ushort v58, v44, s[44:47], s48 offen offset:256
    buffer_load_ushort v59, v44, s[44:47], s49 offen offset:256
    buffer_load_ushort v60, v44, s[44:47], s48 offen offset:512
    buffer_load_ushort v61, v44, s[44:47], s49 offen offset:512
    buffer_load_ushort v62, v44, s[44:47], s48 offen offset:768
    buffer_load_ushort v63, v44, s[44:47], s49 offen offset:768
K1_PREP_N1:
    s_add_u32 s36, s35, 60
    s_lshr_b32 s38, s36, 3
    s_and_b32 s39, s36, 7
    s_lshr_b32 s40, s38, 1
    s_lshl_b32 s40, s40, 3
    s_and_b32 s48, s38, 1
    s_add_u32 s40, s40, s48
    s_lshl_b32 s40, s40, 3
    v_lshl_add_u32 v44, v41, 1, s40
    s_cmp_ge_u32 s39, 4
    s_cbranch_scc1 K1_PREP_M2
    s_lshl_b32 s48, s39, 13
    v_lshl_add_u32 v44, v42, 11, v44
    buffer_load_ushort v64, v44, s[44:47], s48 offen offset:0
    buffer_load_ushort v65, v44, s[44:47], s48 offen offset:256
    buffer_load_ushort v66, v44, s[44:47], s48 offen offset:512
    buffer_load_ushort v67, v44, s[44:47], s48 offen offset:768
    buffer_load_ushort v68, v44, s[44:47], s48 offen offset:1024
    buffer_load_ushort v69, v44, s[44:47], s48 offen offset:1280
    buffer_load_ushort v70, v44, s[44:47], s48 offen offset:1536
    buffer_load_ushort v71, v44, s[44:47], s48 offen offset:1792
    s_branch K1_PREP_N2
K1_PREP_M2:
    s_lshr_b32 s48, s39, 1
    s_lshl_b32 s48, s48, 14
    s_and_b32 s49, s39, 1
    s_lshl_b32 s49, s49, 12
    s_add_u32 s48, s48, s49
    s_add_u32 s49, s48, 8192
    v_lshl_add_u32 v44, v42, 10, v44
    buffer_load_ushort v64, v44, s[44:47], s48 offen offset:0
    buffer_load_ushort v65, v44, s[44:47], s49 offen offset:0
    buffer_load_ushort v66, v44, s[44:47], s48 offen offset:256
    buffer_load_ushort v67, v44, s[44:47], s49 offen offset:256
    buffer_load_ushort v68, v44, s[44:47], s48 offen offset:512
    buffer_load_ushort v69, v44, s[44:47], s49 offen offset:512
    buffer_load_ushort v70, v44, s[44:47], s48 offen offset:768
    buffer_load_ushort v71, v44, s[44:47], s49 offen offset:768
K1_PREP_N2:
    s_cmp_lt_u32 s35, 28
    s_cbranch_scc1 K1_PREP_ST
    v_and_b32 v5, 127, v0
    v_lshlrev_b32 v1, 1, v5
    v_lshlrev_b32 v2, 3, v5
    v_lshlrev_b32 v4, 2, v5
    v_and_b32 v3, 32, v5
    v_add_lshl_u32 v3, v3, v40, 1
    v_lshlrev_b32 v6, 2, v40
    s_add_u32 s64, s26, 65536
    s_addc_u32 s65, s27, 0
    s_add_u32 s58, s32, 16908288
    s_addc_u32 s59, s33, 0
    s_mov_b32 s68, 0xbfb8aa3b
    global_load_ushort v8, v1, s[64:65]
    global_load_ushort v9, v1, s[64:65] offset:256
    global_load_ushort v10, v1, s[64:65] offset:512
    global_load_ushort v11, v1, s[64:65] offset:768
    global_load_ushort v12, v1, s[64:65] offset:1024
    global_load_ushort v13, v3, s[28:29]
    global_load_ushort v14, v3, s[28:29] offset:64
    s_waitcnt vmcnt(0)
    v_lshlrev_b32 v8, 16, v8
    v_mul_f32 v8, s68, v8
    v_lshlrev_b32 v9, 16, v9
    v_mul_f32 v9, s68, v9
    v_lshlrev_b32 v10, 16, v10
    v_mul_f32 v10, s68, v10
    v_lshlrev_b32 v11, 16, v11
    v_mul_f32 v11, s68, v11
    v_lshlrev_b32 v12, 16, v12
    v_mul_f32 v12, s68, v12
    v_cvt_pk_bf16_f32 v16, v9, v10
    v_cvt_pk_bf16_f32 v17, v11, v12
    v_cvt_pk_bf16_f32 v18, v8, 0
    v_lshl_or_b32 v19, v14, 16, v13
    global_store_dwordx2 v2, v[16:17], s[58:59] sc1
    global_store_dword v4, v18, s[58:59] offset:1024 sc1
    global_store_dword v6, v19, s[58:59] offset:1536 sc1
K1_PREP_ST:
    s_waitcnt vmcnt(0)
    s_add_u32 s36, s35, 0
    s_lshl_b32 s50, s36, 10
    v_add_u32 v44, s50, v43
    v_lshl_or_b32 v20, v49, 16, v48
    v_lshl_or_b32 v21, v51, 16, v50
    v_lshl_or_b32 v22, v53, 16, v52
    v_lshl_or_b32 v23, v55, 16, v54
    buffer_store_dwordx4 v[20:23], v44, s[52:55], 0 offen sc1
    s_add_u32 s36, s35, 30
    s_lshl_b32 s50, s36, 10
    v_add_u32 v44, s50, v43
    v_lshl_or_b32 v24, v57, 16, v56
    v_lshl_or_b32 v25, v59, 16, v58
    v_lshl_or_b32 v26, v61, 16, v60
    v_lshl_or_b32 v27, v63, 16, v62
    buffer_store_dwordx4 v[24:27], v44, s[52:55], 0 offen sc1
    s_add_u32 s36, s35, 60
    s_lshl_b32 s50, s36, 10
    v_add_u32 v44, s50, v43
    v_lshl_or_b32 v28, v65, 16, v64
    v_lshl_or_b32 v29, v67, 16, v66
    v_lshl_or_b32 v30, v69, 16, v68
    v_lshl_or_b32 v31, v71, 16, v70
    buffer_store_dwordx4 v[28:31], v44, s[52:55], 0 offen sc1
    s_branch K1_TAIL
K2_OVERFLOW:
    s_lshr_b32 s7, s7, 1
K2_NEXT:
    s_setprio 0
    s_waitcnt vmcnt(0) lgkmcnt(0)
    v_lshrrev_b32 v2, 3, v0
    v_and_b32 v9, 7, v0
    s_mov_b32 s12, 87168
    v_mul_u32_u24 v8, s12, v2
    s_lshl_b32 s14, s2, 4
    s_lshl_b32 s15, s10, 4
    s_add_u32 s15, s15, 4096
    v_add_u32 v8, 5242880, v8
    s_movk_i32 s12, 5120
    buffer_load_ubyte v48, v8, s[24:27], s15 offen offset:15
    buffer_load_dword v49, v8, s[24:27], s12 offen
    s_nop 7
    s_nop 7
    s_barrier
    v_mov_b32 v4, 0
    v_mov_b32 v5, 0
    v_mov_b32 v6, 0
    v_mov_b32 v7, 0
    v_mul_u32_u24 v72, 80, v0
    v_add_u32 v73, 81920, v72
    s_cmp_ge_u32 s3, 12
    ds_write_b128 v72, v[4:7] offset:20368
    ds_write_b128 v72, v[4:7] offset:20384
    ds_write_b32 v72, v4 offset:20400
    s_cbranch_scc1 K2_ZF0
    ds_write_b128 v73, v[4:7] offset:20368
    ds_write_b128 v73, v[4:7] offset:20384
    ds_write_b32 v73, v4 offset:20400
    s_branch K2_ZG0
K2_ZF0:
    v_lshlrev_b32 v75, 4, v0
    s_cmp_eq_u32 s3, 15
    ds_write_b128 v75, v[4:7] offset:896
    s_cbranch_scc1 K2_ZC0
    ds_write_b128 v75, v[4:7] offset:4992
    s_branch K2_ZG0
K2_ZC0:
    v_lshlrev_b32 v11, 2, v0
    ds_write_b32 v11, v4 offset:8704
    ds_write_b32 v4, v4 offset:0
K2_ZG0:
    s_add_u32 s13, s6, s7
    v_add_u32 v9, s6, v9
    v_cmp_gt_u32 vcc, 125, v2
    s_mov_b64 s[44:45], vcc
    s_waitcnt vmcnt(0)
    v_cmp_ne_u32 vcc, 0, v48
    v_lshrrev_b32 v49, 2, v49
    v_mul_u32_u24 v2, 2560, v2
    v_cndmask_b32 v48, 0, v49, vcc
    v_add_u32 v48, 32, v48
    v_cndmask_b32 v48, 0, v48, s[44:45]
    v_cmp_lt_u32 s[48:49], s13, v48
    v_min_u32 v48, s13, v48
    v_mov_b32 v49, s14
    v_mov_b32 v54, s15
    s_mov_b64 s[62:63], -1
    s_mov_b32 s55, 0
    v_add_u32 v10, 0, v9
    v_cmp_lt_u32 s[40:41], v10, v48
    v_cmp_gt_u32 vcc, 16, v10
    v_and_b32 v11, 15, v10
    v_mul_u32_u24 v50, 17, v11
    v_bfe_u32 v50, v50, 3, 4
    v_cndmask_b32 v51, v54, v49, vcc
    v_add3_u32 v50, v50, v51, v8
    v_add_u32 v51, v51, v11
    v_lshl_add_u32 v51, v51, 4, v8
    v_add_u32 v51, 5248, v51
    v_add_u32 v11, v2, v10
    v_cmp_gt_u32 vcc, 32, v10
    v_lshlrev_b32 v52, 2, v11
    v_lshlrev_b32 v53, 4, v11
    v_add_u32 v52, 17825664, v52
    v_add_u32 v53, 19922432, v53
    v_cndmask_b32 v50, v52, v50, vcc
    v_cndmask_b32 v51, v53, v51, vcc
    v_and_b32 v52, -4, v50
    buffer_load_ubyte v96, v50, s[24:27], 0 offen
    buffer_load_dword v56, v52, s[24:27], 0 offen
    buffer_load_dwordx4 v[80:83], v51, s[24:27], 0 offen
    v_add_u32 v10, 8, v9
    v_cmp_lt_u32 s[42:43], v10, v48
    v_cmp_gt_u32 vcc, 16, v10
    v_and_b32 v11, 15, v10
    v_mul_u32_u24 v50, 17, v11
    v_bfe_u32 v50, v50, 3, 4
    v_cndmask_b32 v51, v54, v49, vcc
    v_add3_u32 v50, v50, v51, v8
    v_add_u32 v51, v51, v11
    v_lshl_add_u32 v51, v51, 4, v8
    v_add_u32 v51, 5248, v51
    v_add_u32 v11, v2, v10
    v_cmp_gt_u32 vcc, 32, v10
    v_lshlrev_b32 v52, 2, v11
    v_lshlrev_b32 v53, 4, v11
    v_add_u32 v52, 17825664, v52
    v_add_u32 v53, 19922432, v53
    v_cndmask_b32 v50, v52, v50, vcc
    v_cndmask_b32 v51, v53, v51, vcc
    v_and_b32 v52, -4, v50
    buffer_load_ubyte v97, v50, s[24:27], 0 offen
    buffer_load_dword v57, v52, s[24:27], 0 offen
    buffer_load_dwordx4 v[84:87], v51, s[24:27], 0 offen
    v_add_u32 v10, 16, v9
    v_cmp_lt_u32 s[44:45], v10, v48
    v_cmp_gt_u32 vcc, 16, v10
    v_and_b32 v11, 15, v10
    v_mul_u32_u24 v50, 17, v11
    v_bfe_u32 v50, v50, 3, 4
    v_cndmask_b32 v51, v54, v49, vcc
    v_add3_u32 v50, v50, v51, v8
    v_add_u32 v51, v51, v11
    v_lshl_add_u32 v51, v51, 4, v8
    v_add_u32 v51, 5248, v51
    v_add_u32 v11, v2, v10
    v_cmp_gt_u32 vcc, 32, v10
    v_lshlrev_b32 v52, 2, v11
    v_lshlrev_b32 v53, 4, v11
    v_add_u32 v52, 17825664, v52
    v_add_u32 v53, 19922432, v53
    v_cndmask_b32 v50, v52, v50, vcc
    v_cndmask_b32 v51, v53, v51, vcc
    v_and_b32 v52, -4, v50
    buffer_load_ubyte v98, v50, s[24:27], 0 offen
    buffer_load_dword v58, v52, s[24:27], 0 offen
    buffer_load_dwordx4 v[88:91], v51, s[24:27], 0 offen
    v_add_u32 v10, 24, v9
    v_cmp_lt_u32 s[46:47], v10, v48
    v_cmp_gt_u32 vcc, 16, v10
    v_and_b32 v11, 15, v10
    v_mul_u32_u24 v50, 17, v11
    v_bfe_u32 v50, v50, 3, 4
    v_cndmask_b32 v51, v54, v49, vcc
    v_add3_u32 v50, v50, v51, v8
    v_add_u32 v51, v51, v11
    v_lshl_add_u32 v51, v51, 4, v8
    v_add_u32 v51, 5248, v51
    v_add_u32 v11, v2, v10
    v_cmp_gt_u32 vcc, 32, v10
    v_lshlrev_b32 v52, 2, v11
    v_lshlrev_b32 v53, 4, v11
    v_add_u32 v52, 17825664, v52
    v_add_u32 v53, 19922432, v53
    v_cndmask_b32 v50, v52, v50, vcc
    v_cndmask_b32 v51, v53, v51, vcc
    v_and_b32 v52, -4, v50
    buffer_load_ubyte v99, v50, s[24:27], 0 offen
    buffer_load_dword v59, v52, s[24:27], 0 offen
    buffer_load_dwordx4 v[92:95], v51, s[24:27], 0 offen
    s_and_b32 s8, s2, 3
    s_lshl_b32 s8, s8, 6
    s_waitcnt vmcnt(0) lgkmcnt(0)
    s_barrier
    v_add_u32 v10, 0, v9
    v_lshrrev_b32 v10, 4, v10
    v_lshrrev_b32 v11, 24, v56
    v_xor_b32 v8, s8, v96
    v_add_u32 v8, -1, v8
    v_cmp_eq_u32 vcc, 0, v10
    v_cmp_ne_u32 s[12:13], 0, v96
    s_and_b64 s[12:13], s[12:13], vcc
    v_cmp_lt_u32 vcc, 1, v10
    v_cmp_eq_u32 s[14:15], s2, v11
    s_and_b64 s[14:15], s[14:15], vcc
    s_or_b64 s[12:13], s[12:13], s[14:15]
    v_cmp_eq_u32 vcc, 1, v10
    v_cmp_gt_u32 s[14:15], 61, v8
    s_and_b64 s[14:15], s[14:15], vcc
    s_or_b64 s[12:13], s[12:13], s[14:15]
    s_and_b64 s[40:41], s[40:41], s[12:13]
    v_add_u32 v8, 1, v8
    v_cndmask_b32 v96, v96, v8, vcc
    v_add_u32 v10, 8, v9
    v_lshrrev_b32 v10, 4, v10
    v_lshrrev_b32 v11, 24, v57
    v_xor_b32 v8, s8, v97
    v_add_u32 v8, -1, v8
    v_cmp_eq_u32 vcc, 0, v10
    v_cmp_ne_u32 s[12:13], 0, v97
    s_and_b64 s[12:13], s[12:13], vcc
    v_cmp_lt_u32 vcc, 1, v10
    v_cmp_eq_u32 s[14:15], s2, v11
    s_and_b64 s[14:15], s[14:15], vcc
    s_or_b64 s[12:13], s[12:13], s[14:15]
    v_cmp_eq_u32 vcc, 1, v10
    v_cmp_gt_u32 s[14:15], 61, v8
    s_and_b64 s[14:15], s[14:15], vcc
    s_or_b64 s[12:13], s[12:13], s[14:15]
    s_and_b64 s[42:43], s[42:43], s[12:13]
    v_add_u32 v8, 1, v8
    v_cndmask_b32 v97, v97, v8, vcc
    v_add_u32 v10, 16, v9
    v_lshrrev_b32 v10, 4, v10
    v_lshrrev_b32 v11, 24, v58
    v_xor_b32 v8, s8, v98
    v_add_u32 v8, -1, v8
    v_cmp_eq_u32 vcc, 0, v10
    v_cmp_ne_u32 s[12:13], 0, v98
    s_and_b64 s[12:13], s[12:13], vcc
    v_cmp_lt_u32 vcc, 1, v10
    v_cmp_eq_u32 s[14:15], s2, v11
    s_and_b64 s[14:15], s[14:15], vcc
    s_or_b64 s[12:13], s[12:13], s[14:15]
    v_cmp_eq_u32 vcc, 1, v10
    v_cmp_gt_u32 s[14:15], 61, v8
    s_and_b64 s[14:15], s[14:15], vcc
    s_or_b64 s[12:13], s[12:13], s[14:15]
    s_and_b64 s[44:45], s[44:45], s[12:13]
    v_add_u32 v8, 1, v8
    v_cndmask_b32 v98, v98, v8, vcc
    v_add_u32 v10, 24, v9
    v_lshrrev_b32 v10, 4, v10
    v_lshrrev_b32 v11, 24, v59
    v_xor_b32 v8, s8, v99
    v_add_u32 v8, -1, v8
    v_cmp_eq_u32 vcc, 0, v10
    v_cmp_ne_u32 s[12:13], 0, v99
    s_and_b64 s[12:13], s[12:13], vcc
    v_cmp_lt_u32 vcc, 1, v10
    v_cmp_eq_u32 s[14:15], s2, v11
    s_and_b64 s[14:15], s[14:15], vcc
    s_or_b64 s[12:13], s[12:13], s[14:15]
    v_cmp_eq_u32 vcc, 1, v10
    v_cmp_gt_u32 s[14:15], 61, v8
    s_and_b64 s[14:15], s[14:15], vcc
    s_or_b64 s[12:13], s[12:13], s[14:15]
    s_and_b64 s[46:47], s[46:47], s[12:13]
    v_add_u32 v8, 1, v8
    v_cndmask_b32 v99, v99, v8, vcc
    v_bfe_u32 v9, v0, 5, 1
    v_and_b32 v10, 31, v0
    v_lshlrev_b32 v1, 4, v9
    v_mul_u32_u24 v2, 80, v10
    v_add_u32 v2, v1, v2
    v_lshlrev_b32 v72, 2, v10
    v_lshl_add_u32 v71, v9, 9, v72
    v_lshl_add_u32 v72, s5, 8, v72
    v_bfe_u32 v3, v0, 2, 2
    v_lshl_add_u32 v3, v9, 3, v3
    s_movk_i32 s13, 80
    v_mad_u32_u24 v3, v3, s13, 8
    v_bfe_u32 v10, v0, 4, 1
    v_lshl_add_u32 v3, v10, 5, v3
    v_and_b32 v10, 3, v0
    v_lshl_add_u32 v3, v10, 3, v3
    v_mov_b32 v112, 4294723968
    v_and_b32 v64, 62, v0
    v_bfe_u32 v9, v0, 1, 3
    s_movk_i32 s13, 896
    v_mov_b32 v65, 14076
    v_mad_u32_u24 v65, v9, s13, v65
    v_bfe_u32 v10, v0, 4, 2
    v_and_b32 v66, 1, v0
    v_lshl_add_u32 v66, v10, 1, v66
    v_sub_u32 v67, v66, v9
    v_lshlrev_b32 v66, 3, v66
    v_and_b32 v10, 14, v0
    v_mov_b32 v68, 0x30003
    v_lshlrev_b32 v68, v10, v68
    v_lshlrev_b32 v64, 2, v64
    v_mov_b32 v69, 4
    s_mov_b32 exec_lo, 0xcccc0000
    s_mov_b32 exec_hi, 0xcccc0000
    v_mov_b32 v3, 0x100000
    s_mov_b32 exec_lo, 0x22220000
    s_mov_b32 exec_hi, 0x22220000
    v_subrev_u32 v3, 48, v3
    s_mov_b64 exec, -1
    v_and_b32 v60, 0xf8, v96
    v_lshlrev_b32_sdwa v96, 2, v96 dst_sel:BYTE_0 dst_unused:UNUSED_PAD src0_sel:DWORD src1_sel:DWORD
    v_and_b32 v61, 0xf8, v97
    v_lshlrev_b32_sdwa v97, 2, v97 dst_sel:BYTE_0 dst_unused:UNUSED_PAD src0_sel:DWORD src1_sel:DWORD
    s_mov_b64 exec, s[40:41]
    ds_add_rtn_u32 v100, v60, v69 offset:12544
    v_add_u32 v116, v96, v96
    ds_read_b64 v[116:117], v116 offset:0
    s_mov_b64 exec, s[42:43]
    ds_add_rtn_u32 v101, v61, v69 offset:12544
    v_add_u32 v118, v97, v97
    ds_read_b64 v[118:119], v118 offset:0
    s_mov_b64 exec, -1
    s_branch K2_COMMON
K1_BIN_SP2:
    s_mov_b32 s48, s32
    s_mov_b32 s49, s33
    s_mov_b32 s50, 25165824
    s_mov_b32 s51, 0x20000
    s_mov_b64 exec, s[8:9]
    s_cbranch_execz K1_BIN_O0
    v_lshrrev_b32 v44, 10, v60
    v_mad_u32_u24 v44, v44, 6, v73
    v_and_b32 v45, -4, v44
    ds_read2_b32 v[130:131], v45 offset0:0 offset1:1
    v_mov_b32 v128, v76
    v_mov_b32 v129, v77
    s_waitcnt lgkmcnt(0)
    v_alignbyte_b32 v130, v131, v130, v44
    v_alignbyte_b32 v131, v131, v131, v44
    v_perm_b32 v131, v60, v131, s3
    buffer_store_dwordx4 v[128:131], v84, s[48:51], 0 offen sc1
K1_BIN_O0:
    s_mov_b64 exec, s[10:11]
    s_cbranch_execz K1_BIN_O1
    v_lshrrev_b32 v44, 10, v61
    v_mad_u32_u24 v44, v44, 6, v73
    v_and_b32 v45, -4, v44
    ds_read2_b32 v[134:135], v45 offset0:0 offset1:1
    v_mov_b32 v132, v78
    v_mov_b32 v133, v79
    s_waitcnt lgkmcnt(0)
    v_alignbyte_b32 v134, v135, v134, v44
    v_alignbyte_b32 v135, v135, v135, v44
    v_perm_b32 v135, v61, v135, s3
    buffer_store_dwordx4 v[132:135], v85, s[48:51], 0 offen sc1
K1_BIN_O1:
    s_mov_b64 exec, s[12:13]
    s_cbranch_execz K1_BIN_O2
    v_lshrrev_b32 v44, 10, v62
    v_mad_u32_u24 v44, v44, 6, v73
    v_and_b32 v45, -4, v44
    ds_read2_b32 v[138:139], v45 offset0:0 offset1:1
    v_mov_b32 v136, v80
    v_mov_b32 v137, v81
    s_waitcnt lgkmcnt(0)
    v_alignbyte_b32 v138, v139, v138, v44
    v_alignbyte_b32 v139, v139, v139, v44
    v_perm_b32 v139, v62, v139, s3
    buffer_store_dwordx4 v[136:139], v86, s[48:51], 0 offen sc1
K1_BIN_O2:
    s_mov_b64 exec, s[14:15]
    s_cbranch_execz K1_BIN_O3
    v_lshrrev_b32 v44, 10, v63
    v_mad_u32_u24 v44, v44, 6, v73
    v_and_b32 v45, -4, v44
    ds_read2_b32 v[142:143], v45 offset0:0 offset1:1
    v_mov_b32 v140, v82
    v_mov_b32 v141, v83
    s_waitcnt lgkmcnt(0)
    v_alignbyte_b32 v142, v143, v142, v44
    v_alignbyte_b32 v143, v143, v143, v44
    v_perm_b32 v143, v63, v143, s3
    buffer_store_dwordx4 v[140:143], v87, s[48:51], 0 offen sc1
K1_BIN_O3:
    s_branch K1_BIN_END
K1_BIN_SPILL:
    s_mov_b32 s48, s32
    s_mov_b32 s49, s33
    s_mov_b32 s50, 25165824
    s_mov_b32 s51, 0x20000
    s_lshl_b32 s7, s34, 2
    s_add_u32 s6, s34, 17825792
    s_add_u32 s7, s7, 19922944
    s_mov_b64 exec, s[8:9]
    v_cmpx_lt_u32 vcc, 59, v52
    v_mov_b32 v8, 0
    ds_add_rtn_u32 v8, v8, v57 offset:1280
    v_lshl_or_b32 v4, v48, 22, v60
    s_waitcnt lgkmcnt(0)
    buffer_store_dword v4, v8, s[48:51], s6 offen sc1
    v_lshl_add_u32 v84, v8, 2, s7
    s_mov_b64 exec, s[10:11]
    v_cmpx_lt_u32 vcc, 59, v53
    v_mov_b32 v9, 0
    ds_add_rtn_u32 v9, v9, v57 offset:1280
    v_lshl_or_b32 v5, v49, 22, v61
    s_waitcnt lgkmcnt(0)
    buffer_store_dword v5, v9, s[48:51], s6 offen sc1
    v_lshl_add_u32 v85, v9, 2, s7
    s_mov_b64 exec, s[12:13]
    v_cmpx_lt_u32 vcc, 59, v54
    v_mov_b32 v10, 0
    ds_add_rtn_u32 v10, v10, v57 offset:1280
    v_lshl_or_b32 v6, v50, 22, v62
    s_waitcnt lgkmcnt(0)
    buffer_store_dword v6, v10, s[48:51], s6 offen sc1
    v_lshl_add_u32 v86, v10, 2, s7
    s_mov_b64 exec, s[14:15]
    v_cmpx_lt_u32 vcc, 59, v55
    v_mov_b32 v11, 0
    ds_add_rtn_u32 v11, v11, v57 offset:1280
    v_lshl_or_b32 v7, v51, 22, v63
    s_waitcnt lgkmcnt(0)
    buffer_store_dword v7, v11, s[48:51], s6 offen sc1
    v_lshl_add_u32 v87, v11, 2, s7
    s_branch K1_BIN_NOOV
.section .rodata,"a"
.p2align 6
.amdhsa_kernel egnn_prep_kernel
  .amdhsa_next_free_vgpr 160
  .amdhsa_next_free_sgpr 100
  .amdhsa_accum_offset 160
  .amdhsa_group_segment_fixed_size 0
  .amdhsa_kernarg_size 88
  .amdhsa_user_sgpr_count 2
  .amdhsa_user_sgpr_kernarg_segment_ptr 1
  .amdhsa_system_sgpr_workgroup_id_x 1
.end_amdhsa_kernel
.p2align 6
.amdhsa_kernel gather_scatter__cheap_equivariant_egnn__graph_kernel
  .amdhsa_next_free_vgpr 128
  .amdhsa_next_free_sgpr 100
  .amdhsa_accum_offset 128
  .amdhsa_group_segment_fixed_size 0
  .amdhsa_kernarg_size 88
  .amdhsa_user_sgpr_count 2
  .amdhsa_user_sgpr_kernarg_segment_ptr 1
  .amdhsa_system_sgpr_workgroup_id_x 1
.end_amdhsa_kernel
```
